```python
import torch

def _softmax(x, axis=-1):
    return torch.softmax(x, dim=axis)
def _gelu(x):
    return torch.nn.functional.gelu(x, approximate="tanh")
def _silu(x):
    return torch.nn.functional.silu(x)
def _sigmoid(x):
    return torch.sigmoid(x)
def _layernorm(x, axis=-1, eps=1e-5):
    m = x.mean(dim=axis, keepdim=True)
    v = x.var(dim=axis, keepdim=True, unbiased=False)
    return (x - m) / torch.sqrt(v + eps)
def _scatter_add(tgt, idx, src, axis=0):
    return tgt.clone().index_add_(axis, idx, src)
def _segment_sum(src, seg, n):
    out = torch.zeros((n,) + src.shape[1:], dtype=src.dtype)
    return out.index_add_(0, seg, src)
def _pad(x, pw):
    flat = tuple(v for pair in reversed(pw) for v in pair)
    return torch.nn.functional.pad(x, flat)

kernel_name = 'gated_mix__mha_block__swiglu_ffn__prompt'

def setup_inputs():

    _w = (lambda a: (lambda t: t.to(torch.bfloat16) if t.is_floating_point() else t)(torch.as_tensor(a)))
    def _A_setup():
        B, S, D, H = 1, 2048, 640, 32
        return {
            "x": _w((lambda *s: torch.randn(*s, dtype=torch.bfloat16) * 0.05)(B, S, D)),
            "wqkv": _w((lambda *s: torch.randn(*s, dtype=torch.bfloat16) * 0.8)(D, 3 * D)),
            "wo": _w((lambda *s: torch.randn(*s, dtype=torch.bfloat16) * 0.05)(D, D)),
        }
    _A_in = _A_setup()

    def _B_setup():
        B, S, D, F = 1, 2048, 640, 1728
        return {
            "x": _w((lambda *s: torch.randn(*s, dtype=torch.bfloat16) * 0.05)(B, S, D)),
            "w_gate": _w((lambda *s: torch.randn(*s, dtype=torch.bfloat16) * 0.1)(D, F)),
            "w_up": _w((lambda *s: torch.randn(*s, dtype=torch.bfloat16) * 0.1)(D, F)),
            "w_down": _w((lambda *s: torch.randn(*s, dtype=torch.bfloat16) * 0.1)(F, D)),
        }
    _B_in = _B_setup()

    return {
        "A_x": _A_in["x"],
        "A_wqkv": _A_in["wqkv"],
        "A_wo": _A_in["wo"],
        "B_x": _B_in["x"],
        "B_w_gate": _B_in["w_gate"],
        "B_w_up": _B_in["w_up"],
        "B_w_down": _B_in["w_down"],
        "gate_w": _w((lambda *s: torch.randn(*s, dtype=torch.bfloat16) * 0.05)(640) * 16.0),
    }

def reference(A_x, A_wqkv, A_wo, B_x, B_w_gate, B_w_up, B_w_down, gate_w):
    def _A_ref(x, wqkv, wo):
        B, S, D = x.shape
        H = 32
        Dh = D // H
        qkv = (lambda x, *d: x.permute(*d))((x @ wqkv).reshape(B, S, 3, H, Dh), 2, 0, 3, 1, 4)
        q, k, v = qkv[0], qkv[1], qkv[2]
        scores = torch.einsum("bhqd,bhkd->bhqk", q, k) * (Dh ** -0.5)
        p = _softmax(scores, axis=-1)
        o = torch.einsum("bhqk,bhkd->bhqd", p, v)
        return (lambda x, *d: x.permute(*d))(o, 0, 2, 1, 3).reshape(B, S, D) @ wo

    def _B_ref(x, w_gate, w_up, w_down):
        g = _silu(x @ w_gate)
        u = x @ w_up
        return (g * u) @ w_down

    x = A_x
    g = _sigmoid((x * gate_w).sum(-1, keepdims=True))
    a = _A_ref(x, A_wqkv, A_wo)
    b = _B_ref(x, B_w_gate, B_w_up, B_w_down)
    return g * a + (1 - g) * b
```

```asm
; @launch grid=(512,1,1) block=(512,1,1) lds=81920
.amdgcn_target "amdgcn-amd-amdhsa--gfx950"
.text
.globl gated_mix__mha_block__swiglu_ffn__prompt_kernel
.p2align 8
.type gated_mix__mha_block__swiglu_ffn__prompt_kernel,@function
gated_mix__mha_block__swiglu_ffn__prompt_kernel:
    s_cmp_ge_u32 s2, 512
    s_cbranch_scc1 y_exit
    s_load_dwordx2 s[58:59], s[0:1], 80
    s_cmp_ge_u32 s2, 256
    s_cbranch_scc1 y_g
    s_setprio 2
    s_load_dwordx2 s[4:5], s[0:1], 0
    s_load_dwordx2 s[8:9], s[0:1], 8
    s_load_dwordx2 s[12:13], s[0:1], 80
    s_mov_b32 s6, 2621440
    s_mov_b32 s7, 0x20000
    s_mov_b32 s10, 2457600
    s_mov_b32 s11, 0x20000
    s_mov_b32 s14, 24117248
    s_mov_b32 s15, 0x20000
    v_lshrrev_b32 v8, 6, v0
    v_and_b32 v1, 63, v0
    v_readfirstlane_b32 s16, v8
    s_and_b32 s22, s2, 7
    s_lshr_b32 s23, s2, 3
    s_and_b32 s17, s22, 3
    s_lshl_b32 s17, s17, 2
    s_and_b32 s24, s23, 3
    s_add_u32 s17, s17, s24
    s_lshr_b32 s18, s22, 2
    s_lshl_b32 s18, s18, 3
    s_lshr_b32 s24, s23, 2
    s_add_u32 s18, s18, s24
    s_cmp_eq_u32 s18, 15
    s_cbranch_scc1 q_gate
    s_mul_i32 s19, s17, 163840
    s_lshl_b32 s20, s18, 8
    s_lshl_b32 s21, s16, 11
    v_lshrrev_b32 v8, 3, v1
    s_lshl_b32 s22, s16, 4
    s_add_u32 s22, s22, 0
    v_add_u32 v8, s22, v8
    v_mul_u32_u24 v8, 1280, v8
    v_lshrrev_b32 v9, 4, v1
    v_add_u32 v9, 0, v9
    v_and_b32 v10, 7, v1
    v_xor_b32 v9, v9, v10
    v_lshlrev_b32 v9, 4, v9
    v_add_u32 v2, v8, v9
    v_lshrrev_b32 v8, 3, v1
    s_lshl_b32 s22, s16, 4
    s_add_u32 s22, s22, 8
    v_add_u32 v8, s22, v8
    v_mul_u32_u24 v8, 1280, v8
    v_lshrrev_b32 v9, 4, v1
    v_add_u32 v9, 4, v9
    v_and_b32 v10, 7, v1
    v_xor_b32 v9, v9, v10
    v_lshlrev_b32 v9, 4, v9
    v_add_u32 v3, v8, v9
    v_lshrrev_b32 v8, 4, v1
    s_lshl_b32 s22, s16, 3
    v_add_u32 v9, s22, v8
    v_mul_u32_u24 v9, 3840, v9
    v_bfe_u32 v10, v1, 2, 2
    v_xor_b32 v10, v10, v8
    v_lshlrev_b32 v10, 6, v10
    v_and_b32 v11, 3, v1
    v_lshlrev_b32 v11, 4, v11
    v_add3_u32 v4, v9, v10, v11
    s_lshl_b32 s30, s16, 10
    s_lshl_b32 s22, s16, 2
    s_mul_i32 s22, s22, 3840
    v_subrev_u32 v5, s22, v4
    s_lshr_b32 s22, s2, 3
    s_and_b32 s23, s22, 3
    s_mul_i32 s23, s23, 3
    s_lshr_b32 s22, s22, 2
    s_add_u32 s22, s22, s23
    s_cmp_ge_u32 s22, 10
    s_cselect_b32 s23, 10, 0
    s_sub_u32 s22, s22, s23
    s_mul_i32 s22, s22, 1
    s_lshl_b32 s34, s22, 7
    s_mul_i32 s35, s22, 245760
    s_waitcnt lgkmcnt(0)
    s_mov_b32 s61, 18972672
    s_load_dword s60, s[58:59], s61
    s_add_u32 s22, s19, s34
    s_add_u32 m0, s21, 0
    s_add_u32 s34, s34, 128
    buffer_load_dwordx4 v2, s[4:7], s22 offen lds
    s_add_u32 m0, s21, 1024
    s_cmp_eq_u32 s34, 1280
    buffer_load_dwordx4 v3, s[4:7], s22 offen lds
    s_cselect_b32 s34, 0, s34
    s_add_u32 s22, s20, s35
    s_add_u32 m0, s30, 49152
    s_add_u32 s35, s35, 122880
    buffer_load_dwordx4 v5, s[8:11], s22 offen lds
    s_cmp_eq_u32 s35, 2457600
    s_cselect_b32 s35, 0, s35
    s_add_u32 s22, s20, s35
    s_add_u32 m0, s30, 57344
    s_add_u32 s35, s35, 122880
    buffer_load_dwordx4 v5, s[8:11], s22 offen lds
    s_cmp_eq_u32 s35, 2457600
    s_cselect_b32 s35, 0, s35
    s_barrier
    s_add_u32 s22, s19, s34
    s_add_u32 m0, s21, 16384
    s_add_u32 s34, s34, 128
    buffer_load_dwordx4 v2, s[4:7], s22 offen lds
    s_add_u32 m0, s21, 17408
    s_cmp_eq_u32 s34, 1280
    buffer_load_dwordx4 v3, s[4:7], s22 offen lds
    s_cselect_b32 s34, 0, s34
    s_add_u32 s22, s20, s35
    s_add_u32 m0, s30, 65536
    s_add_u32 s35, s35, 122880
    buffer_load_dwordx4 v5, s[8:11], s22 offen lds
    s_cmp_eq_u32 s35, 2457600
    s_cselect_b32 s35, 0, s35
    v_and_b32 v8, 31, v1
    v_lshrrev_b32 v9, 5, v1
    s_and_b32 s22, s16, 1
    s_lshl_b32 s22, s22, 13
    v_lshlrev_b32 v10, 7, v8
    v_add_u32 v10, s22, v10
    v_bfe_u32 v11, v1, 1, 3
    v_or_b32 v12, 0, v9
    v_xor_b32 v12, v12, v11
    v_lshlrev_b32 v12, 4, v12
    v_add_u32 v88, v10, v12
    v_or_b32 v12, 2, v9
    v_xor_b32 v12, v12, v11
    v_lshlrev_b32 v12, 4, v12
    v_add_u32 v89, v10, v12
    v_or_b32 v12, 4, v9
    v_xor_b32 v12, v12, v11
    v_lshlrev_b32 v12, 4, v12
    v_add_u32 v90, v10, v12
    v_or_b32 v12, 6, v9
    v_xor_b32 v12, v12, v11
    v_lshlrev_b32 v12, 4, v12
    v_add_u32 v91, v10, v12
    v_bfe_u32 v8, v1, 2, 2
    v_lshrrev_b32 v9, 5, v1
    v_lshlrev_b32 v9, 3, v9
    v_add_u32 v9, v9, v8
    v_lshlrev_b32 v9, 8, v9
    s_lshr_b32 s22, s16, 1
    v_xor_b32 v10, s22, v8
    v_lshlrev_b32 v10, 6, v10
    v_bfe_u32 v11, v1, 4, 1
    v_lshlrev_b32 v11, 5, v11
    v_and_b32 v12, 3, v1
    v_lshlrev_b32 v12, 3, v12
    v_add3_u32 v9, v9, v10, v11
    v_add_u32 v9, v9, v12
    v_add_u32 v100, 16384, v9
    v_mov_b32 v32, 0
    v_mov_b32 v33, 0
    v_mov_b32 v34, 0
    v_mov_b32 v35, 0
    v_mov_b32 v36, 0
    v_mov_b32 v37, 0
    v_mov_b32 v38, 0
    v_mov_b32 v39, 0
    v_mov_b32 v40, 0
    v_mov_b32 v41, 0
    v_mov_b32 v42, 0
    v_mov_b32 v43, 0
    v_mov_b32 v44, 0
    v_mov_b32 v45, 0
    v_mov_b32 v46, 0
    v_mov_b32 v47, 0
    v_mov_b32 v48, 0
    v_mov_b32 v49, 0
    v_mov_b32 v50, 0
    v_mov_b32 v51, 0
    v_mov_b32 v52, 0
    v_mov_b32 v53, 0
    v_mov_b32 v54, 0
    v_mov_b32 v55, 0
    v_mov_b32 v56, 0
    v_mov_b32 v57, 0
    v_mov_b32 v58, 0
    v_mov_b32 v59, 0
    v_mov_b32 v60, 0
    v_mov_b32 v61, 0
    v_mov_b32 v62, 0
    v_mov_b32 v63, 0
    s_cmp_ge_u32 s18, 10
    s_cbranch_scc1 q_vpart
    s_waitcnt vmcnt(4)
    s_barrier
    ds_read_b128 v[64:67], v88 offset:0
    ds_read_b128 v[68:71], v88 offset:4096
    ds_read_b64_tr_b16 v[72:73], v100 offset:32768
    ds_read_b64_tr_b16 v[74:75], v100 offset:33792
    ds_read_b128 v[76:79], v89 offset:0
    ds_read_b128 v[80:83], v89 offset:4096
    ds_read_b64_tr_b16 v[84:85], v100 offset:36864
    ds_read_b64_tr_b16 v[86:87], v100 offset:37888
    s_waitcnt lgkmcnt(4)
    v_mfma_f32_32x32x16_bf16 v[32:47], v[72:75], v[64:67], v[32:47]
    v_mfma_f32_32x32x16_bf16 v[48:63], v[72:75], v[68:71], v[48:63]
    s_add_u32 s22, s20, s35
    s_add_u32 m0, s30, 73728
    s_add_u32 s35, s35, 122880
    buffer_load_dwordx4 v5, s[8:11], s22 offen lds
    s_cmp_eq_u32 s35, 2457600
    s_cselect_b32 s35, 0, s35
    s_add_u32 s22, s19, s34
    s_add_u32 m0, s21, 32768
    s_add_u32 s34, s34, 128
    buffer_load_dwordx4 v2, s[4:7], s22 offen lds
    s_add_u32 m0, s21, 33792
    s_cmp_eq_u32 s34, 1280
    buffer_load_dwordx4 v3, s[4:7], s22 offen lds
    s_cselect_b32 s34, 0, s34
    s_waitcnt lgkmcnt(0)
    v_mfma_f32_32x32x16_bf16 v[32:47], v[84:87], v[76:79], v[32:47]
    v_mfma_f32_32x32x16_bf16 v[48:63], v[84:87], v[80:83], v[48:63]
    s_add_u32 s60, s60, 0x9e3779b9
    s_waitcnt vmcnt(6)
    s_barrier
    ds_read_b128 v[64:67], v90 offset:0
    ds_read_b128 v[68:71], v90 offset:4096
    ds_read_b64_tr_b16 v[72:73], v100 offset:40960
    ds_read_b64_tr_b16 v[74:75], v100 offset:41984
    ds_read_b128 v[76:79], v91 offset:0
    ds_read_b128 v[80:83], v91 offset:4096
    ds_read_b64_tr_b16 v[84:85], v100 offset:45056
    ds_read_b64_tr_b16 v[86:87], v100 offset:46080
    s_waitcnt lgkmcnt(4)
    v_mfma_f32_32x32x16_bf16 v[32:47], v[72:75], v[64:67], v[32:47]
    v_mfma_f32_32x32x16_bf16 v[48:63], v[72:75], v[68:71], v[48:63]
    s_add_u32 s22, s20, s35
    s_add_u32 m0, s30, 49152
    s_add_u32 s35, s35, 122880
    buffer_load_dwordx4 v5, s[8:11], s22 offen lds
    s_cmp_eq_u32 s35, 2457600
    s_cselect_b32 s35, 0, s35
    s_waitcnt lgkmcnt(0)
    v_mfma_f32_32x32x16_bf16 v[32:47], v[84:87], v[76:79], v[32:47]
    v_mfma_f32_32x32x16_bf16 v[48:63], v[84:87], v[80:83], v[48:63]
    s_waitcnt vmcnt(4)
    s_barrier
    ds_read_b128 v[64:67], v88 offset:16384
    ds_read_b128 v[68:71], v88 offset:20480
    ds_read_b64_tr_b16 v[72:73], v100 offset:49152
    ds_read_b64_tr_b16 v[74:75], v100 offset:50176
    ds_read_b128 v[76:79], v89 offset:16384
    ds_read_b128 v[80:83], v89 offset:20480
    ds_read_b64_tr_b16 v[84:85], v100 offset:53248
    ds_read_b64_tr_b16 v[86:87], v100 offset:54272
    s_waitcnt lgkmcnt(4)
    v_mfma_f32_32x32x16_bf16 v[32:47], v[72:75], v[64:67], v[32:47]
    v_mfma_f32_32x32x16_bf16 v[48:63], v[72:75], v[68:71], v[48:63]
    s_add_u32 s22, s20, s35
    s_add_u32 m0, s30, 57344
    s_add_u32 s35, s35, 122880
    buffer_load_dwordx4 v5, s[8:11], s22 offen lds
    s_cmp_eq_u32 s35, 2457600
    s_cselect_b32 s35, 0, s35
    s_add_u32 s22, s19, s34
    s_add_u32 m0, s21, 0
    s_add_u32 s34, s34, 128
    buffer_load_dwordx4 v2, s[4:7], s22 offen lds
    s_add_u32 m0, s21, 1024
    s_cmp_eq_u32 s34, 1280
    buffer_load_dwordx4 v3, s[4:7], s22 offen lds
    s_cselect_b32 s34, 0, s34
    s_waitcnt lgkmcnt(0)
    v_mfma_f32_32x32x16_bf16 v[32:47], v[84:87], v[76:79], v[32:47]
    v_mfma_f32_32x32x16_bf16 v[48:63], v[84:87], v[80:83], v[48:63]
    s_waitcnt vmcnt(6)
    s_barrier
    ds_read_b128 v[64:67], v90 offset:16384
    ds_read_b128 v[68:71], v90 offset:20480
    ds_read_b64_tr_b16 v[72:73], v100 offset:57344
    ds_read_b64_tr_b16 v[74:75], v100 offset:58368
    ds_read_b128 v[76:79], v91 offset:16384
    ds_read_b128 v[80:83], v91 offset:20480
    ds_read_b64_tr_b16 v[84:85], v100 offset:61440
    ds_read_b64_tr_b16 v[86:87], v100 offset:62464
    s_waitcnt lgkmcnt(4)
    v_mfma_f32_32x32x16_bf16 v[32:47], v[72:75], v[64:67], v[32:47]
    v_mfma_f32_32x32x16_bf16 v[48:63], v[72:75], v[68:71], v[48:63]
    s_add_u32 s22, s20, s35
    s_add_u32 m0, s30, 65536
    s_add_u32 s35, s35, 122880
    buffer_load_dwordx4 v5, s[8:11], s22 offen lds
    s_cmp_eq_u32 s35, 2457600
    s_cselect_b32 s35, 0, s35
    s_waitcnt lgkmcnt(0)
    v_mfma_f32_32x32x16_bf16 v[32:47], v[84:87], v[76:79], v[32:47]
    v_mfma_f32_32x32x16_bf16 v[48:63], v[84:87], v[80:83], v[48:63]
    s_waitcnt vmcnt(4)
    s_barrier
    ds_read_b128 v[64:67], v88 offset:32768
    ds_read_b128 v[68:71], v88 offset:36864
    ds_read_b64_tr_b16 v[72:73], v100 offset:32768
    ds_read_b64_tr_b16 v[74:75], v100 offset:33792
    ds_read_b128 v[76:79], v89 offset:32768
    ds_read_b128 v[80:83], v89 offset:36864
    ds_read_b64_tr_b16 v[84:85], v100 offset:36864
    ds_read_b64_tr_b16 v[86:87], v100 offset:37888
    s_waitcnt lgkmcnt(4)
    v_mfma_f32_32x32x16_bf16 v[32:47], v[72:75], v[64:67], v[32:47]
    v_mfma_f32_32x32x16_bf16 v[48:63], v[72:75], v[68:71], v[48:63]
    s_add_u32 s22, s20, s35
    s_add_u32 m0, s30, 73728
    s_add_u32 s35, s35, 122880
    buffer_load_dwordx4 v5, s[8:11], s22 offen lds
    s_cmp_eq_u32 s35, 2457600
    s_cselect_b32 s35, 0, s35
    s_add_u32 s22, s19, s34
    s_add_u32 m0, s21, 16384
    s_add_u32 s34, s34, 128
    buffer_load_dwordx4 v2, s[4:7], s22 offen lds
    s_add_u32 m0, s21, 17408
    s_cmp_eq_u32 s34, 1280
    buffer_load_dwordx4 v3, s[4:7], s22 offen lds
    s_cselect_b32 s34, 0, s34
    s_waitcnt lgkmcnt(0)
    v_mfma_f32_32x32x16_bf16 v[32:47], v[84:87], v[76:79], v[32:47]
    v_mfma_f32_32x32x16_bf16 v[48:63], v[84:87], v[80:83], v[48:63]
    s_waitcnt vmcnt(6)
    s_barrier
    ds_read_b128 v[64:67], v90 offset:32768
    ds_read_b128 v[68:71], v90 offset:36864
    ds_read_b64_tr_b16 v[72:73], v100 offset:40960
    ds_read_b64_tr_b16 v[74:75], v100 offset:41984
    ds_read_b128 v[76:79], v91 offset:32768
    ds_read_b128 v[80:83], v91 offset:36864
    ds_read_b64_tr_b16 v[84:85], v100 offset:45056
    ds_read_b64_tr_b16 v[86:87], v100 offset:46080
    s_waitcnt lgkmcnt(4)
    v_mfma_f32_32x32x16_bf16 v[32:47], v[72:75], v[64:67], v[32:47]
    v_mfma_f32_32x32x16_bf16 v[48:63], v[72:75], v[68:71], v[48:63]
    s_add_u32 s22, s20, s35
    s_add_u32 m0, s30, 49152
    s_add_u32 s35, s35, 122880
    buffer_load_dwordx4 v5, s[8:11], s22 offen lds
    s_cmp_eq_u32 s35, 2457600
    s_cselect_b32 s35, 0, s35
    s_waitcnt lgkmcnt(0)
    v_mfma_f32_32x32x16_bf16 v[32:47], v[84:87], v[76:79], v[32:47]
    v_mfma_f32_32x32x16_bf16 v[48:63], v[84:87], v[80:83], v[48:63]
    s_waitcnt vmcnt(4)
    s_barrier
    ds_read_b128 v[64:67], v88 offset:0
    ds_read_b128 v[68:71], v88 offset:4096
    ds_read_b64_tr_b16 v[72:73], v100 offset:49152
    ds_read_b64_tr_b16 v[74:75], v100 offset:50176
    ds_read_b128 v[76:79], v89 offset:0
    ds_read_b128 v[80:83], v89 offset:4096
    ds_read_b64_tr_b16 v[84:85], v100 offset:53248
    ds_read_b64_tr_b16 v[86:87], v100 offset:54272
    s_waitcnt lgkmcnt(4)
    v_mfma_f32_32x32x16_bf16 v[32:47], v[72:75], v[64:67], v[32:47]
    v_mfma_f32_32x32x16_bf16 v[48:63], v[72:75], v[68:71], v[48:63]
    s_add_u32 s22, s20, s35
    s_add_u32 m0, s30, 57344
    s_add_u32 s35, s35, 122880
    buffer_load_dwordx4 v5, s[8:11], s22 offen lds
    s_cmp_eq_u32 s35, 2457600
    s_cselect_b32 s35, 0, s35
    s_add_u32 s22, s19, s34
    s_add_u32 m0, s21, 32768
    s_add_u32 s34, s34, 128
    buffer_load_dwordx4 v2, s[4:7], s22 offen lds
    s_add_u32 m0, s21, 33792
    s_cmp_eq_u32 s34, 1280
    buffer_load_dwordx4 v3, s[4:7], s22 offen lds
    s_cselect_b32 s34, 0, s34
    s_waitcnt lgkmcnt(0)
    v_mfma_f32_32x32x16_bf16 v[32:47], v[84:87], v[76:79], v[32:47]
    v_mfma_f32_32x32x16_bf16 v[48:63], v[84:87], v[80:83], v[48:63]
    s_waitcnt vmcnt(6)
    s_barrier
    ds_read_b128 v[64:67], v90 offset:0
    ds_read_b128 v[68:71], v90 offset:4096
    ds_read_b64_tr_b16 v[72:73], v100 offset:57344
    ds_read_b64_tr_b16 v[74:75], v100 offset:58368
    ds_read_b128 v[76:79], v91 offset:0
    ds_read_b128 v[80:83], v91 offset:4096
    ds_read_b64_tr_b16 v[84:85], v100 offset:61440
    ds_read_b64_tr_b16 v[86:87], v100 offset:62464
    s_waitcnt lgkmcnt(4)
    v_mfma_f32_32x32x16_bf16 v[32:47], v[72:75], v[64:67], v[32:47]
    v_mfma_f32_32x32x16_bf16 v[48:63], v[72:75], v[68:71], v[48:63]
    s_add_u32 s22, s20, s35
    s_add_u32 m0, s30, 65536
    s_add_u32 s35, s35, 122880
    buffer_load_dwordx4 v5, s[8:11], s22 offen lds
    s_cmp_eq_u32 s35, 2457600
    s_cselect_b32 s35, 0, s35
    s_waitcnt lgkmcnt(0)
    v_mfma_f32_32x32x16_bf16 v[32:47], v[84:87], v[76:79], v[32:47]
    v_mfma_f32_32x32x16_bf16 v[48:63], v[84:87], v[80:83], v[48:63]
    s_waitcnt vmcnt(4)
    s_barrier
    ds_read_b128 v[64:67], v88 offset:16384
    ds_read_b128 v[68:71], v88 offset:20480
    ds_read_b64_tr_b16 v[72:73], v100 offset:32768
    ds_read_b64_tr_b16 v[74:75], v100 offset:33792
    ds_read_b128 v[76:79], v89 offset:16384
    ds_read_b128 v[80:83], v89 offset:20480
    ds_read_b64_tr_b16 v[84:85], v100 offset:36864
    ds_read_b64_tr_b16 v[86:87], v100 offset:37888
    s_waitcnt lgkmcnt(4)
    v_mfma_f32_32x32x16_bf16 v[32:47], v[72:75], v[64:67], v[32:47]
    v_mfma_f32_32x32x16_bf16 v[48:63], v[72:75], v[68:71], v[48:63]
    s_add_u32 s22, s20, s35
    s_add_u32 m0, s30, 73728
    s_add_u32 s35, s35, 122880
    buffer_load_dwordx4 v5, s[8:11], s22 offen lds
    s_cmp_eq_u32 s35, 2457600
    s_cselect_b32 s35, 0, s35
    s_add_u32 s22, s19, s34
    s_add_u32 m0, s21, 0
    s_add_u32 s34, s34, 128
    buffer_load_dwordx4 v2, s[4:7], s22 offen lds
    s_add_u32 m0, s21, 1024
    s_cmp_eq_u32 s34, 1280
    buffer_load_dwordx4 v3, s[4:7], s22 offen lds
    s_cselect_b32 s34, 0, s34
    s_waitcnt lgkmcnt(0)
    v_mfma_f32_32x32x16_bf16 v[32:47], v[84:87], v[76:79], v[32:47]
    v_mfma_f32_32x32x16_bf16 v[48:63], v[84:87], v[80:83], v[48:63]
    s_waitcnt vmcnt(6)
    s_barrier
    ds_read_b128 v[64:67], v90 offset:16384
    ds_read_b128 v[68:71], v90 offset:20480
    ds_read_b64_tr_b16 v[72:73], v100 offset:40960
    ds_read_b64_tr_b16 v[74:75], v100 offset:41984
    ds_read_b128 v[76:79], v91 offset:16384
    ds_read_b128 v[80:83], v91 offset:20480
    ds_read_b64_tr_b16 v[84:85], v100 offset:45056
    ds_read_b64_tr_b16 v[86:87], v100 offset:46080
    s_waitcnt lgkmcnt(4)
    v_mfma_f32_32x32x16_bf16 v[32:47], v[72:75], v[64:67], v[32:47]
    v_mfma_f32_32x32x16_bf16 v[48:63], v[72:75], v[68:71], v[48:63]
    s_add_u32 s22, s20, s35
    s_add_u32 m0, s30, 49152
    s_add_u32 s35, s35, 122880
    buffer_load_dwordx4 v5, s[8:11], s22 offen lds
    s_cmp_eq_u32 s35, 2457600
    s_cselect_b32 s35, 0, s35
    s_waitcnt lgkmcnt(0)
    v_mfma_f32_32x32x16_bf16 v[32:47], v[84:87], v[76:79], v[32:47]
    v_mfma_f32_32x32x16_bf16 v[48:63], v[84:87], v[80:83], v[48:63]
    s_waitcnt vmcnt(4)
    s_barrier
    ds_read_b128 v[64:67], v88 offset:32768
    ds_read_b128 v[68:71], v88 offset:36864
    ds_read_b64_tr_b16 v[72:73], v100 offset:49152
    ds_read_b64_tr_b16 v[74:75], v100 offset:50176
    ds_read_b128 v[76:79], v89 offset:32768
    ds_read_b128 v[80:83], v89 offset:36864
    ds_read_b64_tr_b16 v[84:85], v100 offset:53248
    ds_read_b64_tr_b16 v[86:87], v100 offset:54272
    s_waitcnt lgkmcnt(4)
    v_mfma_f32_32x32x16_bf16 v[32:47], v[72:75], v[64:67], v[32:47]
    v_mfma_f32_32x32x16_bf16 v[48:63], v[72:75], v[68:71], v[48:63]
    s_add_u32 s22, s20, s35
    s_add_u32 m0, s30, 57344
    s_add_u32 s35, s35, 122880
    buffer_load_dwordx4 v5, s[8:11], s22 offen lds
    s_cmp_eq_u32 s35, 2457600
    s_cselect_b32 s35, 0, s35
    s_add_u32 s22, s19, s34
    s_add_u32 m0, s21, 16384
    s_add_u32 s34, s34, 128
    buffer_load_dwordx4 v2, s[4:7], s22 offen lds
    s_add_u32 m0, s21, 17408
    s_cmp_eq_u32 s34, 1280
    buffer_load_dwordx4 v3, s[4:7], s22 offen lds
    s_cselect_b32 s34, 0, s34
    s_waitcnt lgkmcnt(0)
    v_mfma_f32_32x32x16_bf16 v[32:47], v[84:87], v[76:79], v[32:47]
    v_mfma_f32_32x32x16_bf16 v[48:63], v[84:87], v[80:83], v[48:63]
    s_waitcnt vmcnt(6)
    s_barrier
    ds_read_b128 v[64:67], v90 offset:32768
    ds_read_b128 v[68:71], v90 offset:36864
    ds_read_b64_tr_b16 v[72:73], v100 offset:57344
    ds_read_b64_tr_b16 v[74:75], v100 offset:58368
    ds_read_b128 v[76:79], v91 offset:32768
    ds_read_b128 v[80:83], v91 offset:36864
    ds_read_b64_tr_b16 v[84:85], v100 offset:61440
    ds_read_b64_tr_b16 v[86:87], v100 offset:62464
    s_waitcnt lgkmcnt(4)
    v_mfma_f32_32x32x16_bf16 v[32:47], v[72:75], v[64:67], v[32:47]
    v_mfma_f32_32x32x16_bf16 v[48:63], v[72:75], v[68:71], v[48:63]
    s_add_u32 s22, s20, s35
    s_add_u32 m0, s30, 65536
    s_add_u32 s35, s35, 122880
    buffer_load_dwordx4 v5, s[8:11], s22 offen lds
    s_cmp_eq_u32 s35, 2457600
    s_cselect_b32 s35, 0, s35
    s_waitcnt lgkmcnt(0)
    v_mfma_f32_32x32x16_bf16 v[32:47], v[84:87], v[76:79], v[32:47]
    v_mfma_f32_32x32x16_bf16 v[48:63], v[84:87], v[80:83], v[48:63]
    s_waitcnt vmcnt(4)
    s_barrier
    ds_read_b128 v[64:67], v88 offset:0
    ds_read_b128 v[68:71], v88 offset:4096
    ds_read_b64_tr_b16 v[72:73], v100 offset:32768
    ds_read_b64_tr_b16 v[74:75], v100 offset:33792
    ds_read_b128 v[76:79], v89 offset:0
    ds_read_b128 v[80:83], v89 offset:4096
    ds_read_b64_tr_b16 v[84:85], v100 offset:36864
    ds_read_b64_tr_b16 v[86:87], v100 offset:37888
    s_waitcnt lgkmcnt(4)
    v_mfma_f32_32x32x16_bf16 v[32:47], v[72:75], v[64:67], v[32:47]
    v_mfma_f32_32x32x16_bf16 v[48:63], v[72:75], v[68:71], v[48:63]
    s_add_u32 s22, s20, s35
    s_add_u32 m0, s30, 73728
    s_add_u32 s35, s35, 122880
    buffer_load_dwordx4 v5, s[8:11], s22 offen lds
    s_cmp_eq_u32 s35, 2457600
    s_cselect_b32 s35, 0, s35
    s_add_u32 s22, s19, s34
    s_add_u32 m0, s21, 32768
    s_add_u32 s34, s34, 128
    buffer_load_dwordx4 v2, s[4:7], s22 offen lds
    s_add_u32 m0, s21, 33792
    s_cmp_eq_u32 s34, 1280
    buffer_load_dwordx4 v3, s[4:7], s22 offen lds
    s_cselect_b32 s34, 0, s34
    s_waitcnt lgkmcnt(0)
    v_mfma_f32_32x32x16_bf16 v[32:47], v[84:87], v[76:79], v[32:47]
    v_mfma_f32_32x32x16_bf16 v[48:63], v[84:87], v[80:83], v[48:63]
    s_waitcnt vmcnt(6)
    s_barrier
    ds_read_b128 v[64:67], v90 offset:0
    ds_read_b128 v[68:71], v90 offset:4096
    ds_read_b64_tr_b16 v[72:73], v100 offset:40960
    ds_read_b64_tr_b16 v[74:75], v100 offset:41984
    ds_read_b128 v[76:79], v91 offset:0
    ds_read_b128 v[80:83], v91 offset:4096
    ds_read_b64_tr_b16 v[84:85], v100 offset:45056
    ds_read_b64_tr_b16 v[86:87], v100 offset:46080
    s_waitcnt lgkmcnt(4)
    v_mfma_f32_32x32x16_bf16 v[32:47], v[72:75], v[64:67], v[32:47]
    v_mfma_f32_32x32x16_bf16 v[48:63], v[72:75], v[68:71], v[48:63]
    s_add_u32 s22, s20, s35
    s_add_u32 m0, s30, 49152
    s_add_u32 s35, s35, 122880
    buffer_load_dwordx4 v5, s[8:11], s22 offen lds
    s_cmp_eq_u32 s35, 2457600
    s_cselect_b32 s35, 0, s35
    s_waitcnt lgkmcnt(0)
    v_mfma_f32_32x32x16_bf16 v[32:47], v[84:87], v[76:79], v[32:47]
    v_mfma_f32_32x32x16_bf16 v[48:63], v[84:87], v[80:83], v[48:63]
    s_waitcnt vmcnt(4)
    s_barrier
    ds_read_b128 v[64:67], v88 offset:16384
    ds_read_b128 v[68:71], v88 offset:20480
    ds_read_b64_tr_b16 v[72:73], v100 offset:49152
    ds_read_b64_tr_b16 v[74:75], v100 offset:50176
    ds_read_b128 v[76:79], v89 offset:16384
    ds_read_b128 v[80:83], v89 offset:20480
    ds_read_b64_tr_b16 v[84:85], v100 offset:53248
    ds_read_b64_tr_b16 v[86:87], v100 offset:54272
    s_waitcnt lgkmcnt(4)
    v_mfma_f32_32x32x16_bf16 v[32:47], v[72:75], v[64:67], v[32:47]
    v_mfma_f32_32x32x16_bf16 v[48:63], v[72:75], v[68:71], v[48:63]
    s_add_u32 s22, s20, s35
    s_add_u32 m0, s30, 57344
    s_add_u32 s35, s35, 122880
    buffer_load_dwordx4 v5, s[8:11], s22 offen lds
    s_cmp_eq_u32 s35, 2457600
    s_cselect_b32 s35, 0, s35
    s_add_u32 s22, s19, s34
    s_add_u32 m0, s21, 0
    s_add_u32 s34, s34, 128
    buffer_load_dwordx4 v2, s[4:7], s22 offen lds
    s_add_u32 m0, s21, 1024
    s_cmp_eq_u32 s34, 1280
    buffer_load_dwordx4 v3, s[4:7], s22 offen lds
    s_cselect_b32 s34, 0, s34
    s_waitcnt lgkmcnt(0)
    v_mfma_f32_32x32x16_bf16 v[32:47], v[84:87], v[76:79], v[32:47]
    v_mfma_f32_32x32x16_bf16 v[48:63], v[84:87], v[80:83], v[48:63]
    s_waitcnt vmcnt(6)
    s_barrier
    ds_read_b128 v[64:67], v90 offset:16384
    ds_read_b128 v[68:71], v90 offset:20480
    ds_read_b64_tr_b16 v[72:73], v100 offset:57344
    ds_read_b64_tr_b16 v[74:75], v100 offset:58368
    ds_read_b128 v[76:79], v91 offset:16384
    ds_read_b128 v[80:83], v91 offset:20480
    ds_read_b64_tr_b16 v[84:85], v100 offset:61440
    ds_read_b64_tr_b16 v[86:87], v100 offset:62464
    s_waitcnt lgkmcnt(4)
    v_mfma_f32_32x32x16_bf16 v[32:47], v[72:75], v[64:67], v[32:47]
    v_mfma_f32_32x32x16_bf16 v[48:63], v[72:75], v[68:71], v[48:63]
    s_add_u32 s22, s20, s35
    s_add_u32 m0, s30, 65536
    s_add_u32 s35, s35, 122880
    buffer_load_dwordx4 v5, s[8:11], s22 offen lds
    s_cmp_eq_u32 s35, 2457600
    s_cselect_b32 s35, 0, s35
    s_waitcnt lgkmcnt(0)
    v_mfma_f32_32x32x16_bf16 v[32:47], v[84:87], v[76:79], v[32:47]
    v_mfma_f32_32x32x16_bf16 v[48:63], v[84:87], v[80:83], v[48:63]
    s_waitcnt vmcnt(4)
    s_barrier
    ds_read_b128 v[64:67], v88 offset:32768
    ds_read_b128 v[68:71], v88 offset:36864
    ds_read_b64_tr_b16 v[72:73], v100 offset:32768
    ds_read_b64_tr_b16 v[74:75], v100 offset:33792
    ds_read_b128 v[76:79], v89 offset:32768
    ds_read_b128 v[80:83], v89 offset:36864
    ds_read_b64_tr_b16 v[84:85], v100 offset:36864
    ds_read_b64_tr_b16 v[86:87], v100 offset:37888
    s_waitcnt lgkmcnt(4)
    v_mfma_f32_32x32x16_bf16 v[32:47], v[72:75], v[64:67], v[32:47]
    v_mfma_f32_32x32x16_bf16 v[48:63], v[72:75], v[68:71], v[48:63]
    s_add_u32 s22, s20, s35
    s_add_u32 m0, s30, 73728
    s_add_u32 s35, s35, 122880
    buffer_load_dwordx4 v5, s[8:11], s22 offen lds
    s_cmp_eq_u32 s35, 2457600
    s_cselect_b32 s35, 0, s35
    s_waitcnt lgkmcnt(0)
    v_mfma_f32_32x32x16_bf16 v[32:47], v[84:87], v[76:79], v[32:47]
    v_mfma_f32_32x32x16_bf16 v[48:63], v[84:87], v[80:83], v[48:63]
    s_waitcnt vmcnt(4)
    s_barrier
    ds_read_b128 v[64:67], v90 offset:32768
    ds_read_b128 v[68:71], v90 offset:36864
    ds_read_b64_tr_b16 v[72:73], v100 offset:40960
    ds_read_b64_tr_b16 v[74:75], v100 offset:41984
    ds_read_b128 v[76:79], v91 offset:32768
    ds_read_b128 v[80:83], v91 offset:36864
    ds_read_b64_tr_b16 v[84:85], v100 offset:45056
    ds_read_b64_tr_b16 v[86:87], v100 offset:46080
    s_waitcnt lgkmcnt(4)
    v_mfma_f32_32x32x16_bf16 v[32:47], v[72:75], v[64:67], v[32:47]
    v_mfma_f32_32x32x16_bf16 v[48:63], v[72:75], v[68:71], v[48:63]
    s_waitcnt lgkmcnt(0)
    v_mfma_f32_32x32x16_bf16 v[32:47], v[84:87], v[76:79], v[32:47]
    v_mfma_f32_32x32x16_bf16 v[48:63], v[84:87], v[80:83], v[48:63]
    s_waitcnt vmcnt(1)
    s_barrier
    ds_read_b128 v[64:67], v88 offset:0
    ds_read_b128 v[68:71], v88 offset:4096
    ds_read_b64_tr_b16 v[72:73], v100 offset:49152
    ds_read_b64_tr_b16 v[74:75], v100 offset:50176
    ds_read_b128 v[76:79], v89 offset:0
    ds_read_b128 v[80:83], v89 offset:4096
    ds_read_b64_tr_b16 v[84:85], v100 offset:53248
    ds_read_b64_tr_b16 v[86:87], v100 offset:54272
    s_waitcnt lgkmcnt(4)
    v_mfma_f32_32x32x16_bf16 v[32:47], v[72:75], v[64:67], v[32:47]
    v_mfma_f32_32x32x16_bf16 v[48:63], v[72:75], v[68:71], v[48:63]
    s_waitcnt lgkmcnt(0)
    v_mfma_f32_32x32x16_bf16 v[32:47], v[84:87], v[76:79], v[32:47]
    v_mfma_f32_32x32x16_bf16 v[48:63], v[84:87], v[80:83], v[48:63]
    s_waitcnt vmcnt(0)
    s_barrier
    ds_read_b128 v[64:67], v90 offset:0
    ds_read_b128 v[68:71], v90 offset:4096
    ds_read_b64_tr_b16 v[72:73], v100 offset:57344
    ds_read_b64_tr_b16 v[74:75], v100 offset:58368
    ds_read_b128 v[76:79], v91 offset:0
    ds_read_b128 v[80:83], v91 offset:4096
    ds_read_b64_tr_b16 v[84:85], v100 offset:61440
    ds_read_b64_tr_b16 v[86:87], v100 offset:62464
    s_waitcnt lgkmcnt(4)
    v_mfma_f32_32x32x16_bf16 v[32:47], v[72:75], v[64:67], v[32:47]
    v_mfma_f32_32x32x16_bf16 v[48:63], v[72:75], v[68:71], v[48:63]
    s_waitcnt lgkmcnt(0)
    v_mfma_f32_32x32x16_bf16 v[32:47], v[84:87], v[76:79], v[32:47]
    v_mfma_f32_32x32x16_bf16 v[48:63], v[84:87], v[80:83], v[48:63]
    s_cmp_lt_u32 s18, 5
    s_cselect_b32 s23, 1051011932, 1.0
    s_cselect_b32 s24, 0, 2621440
    s_cselect_b32 s22, 0, 160
    s_lshl_b32 s25, s18, 5
    s_lshr_b32 s26, s16, 1
    s_lshl_b32 s26, s26, 3
    s_add_u32 s25, s25, s26
    s_sub_u32 s25, s25, s22
    s_and_b32 s26, s16, 1
    s_lshl_b32 s26, s26, 9
    s_mul_i32 s27, s17, 5120
    s_add_u32 s27, s27, s26
    s_add_u32 s27, s27, s24
    v_and_b32 v8, 31, v1
    v_lshlrev_b32 v8, 3, v8
    v_lshrrev_b32 v9, 5, v1
    v_add_u32 v9, s25, v9
    s_mov_b32 s28, 52429
    s_mov_b32 s29, 81920
    v_add_u32 v10, 0, v9
    v_mul_lo_u32 v11, v10, s28
    v_lshrrev_b32 v11, 18, v11
    v_mul_u32_u24 v12, 5, v11
    v_sub_u32 v12, v10, v12
    v_mul_lo_u32 v11, v11, s29
    v_and_b32 v13, 1, v12
    v_lshlrev_b32 v13, 1, v13
    v_lshrrev_b32 v17, 1, v12
    v_or_b32 v13, v13, v17
    v_cmp_eq_u32 vcc, 4, v12
    s_nop 1
    v_cndmask_b32 v13, v13, v12, vcc
    v_lshlrev_b32 v13, 10, v13
    v_add3_u32 v13, v13, v11, v8
    v_add_u32 v10, 2, v9
    v_mul_lo_u32 v11, v10, s28
    v_lshrrev_b32 v11, 18, v11
    v_mul_u32_u24 v12, 5, v11
    v_sub_u32 v12, v10, v12
    v_mul_lo_u32 v11, v11, s29
    v_and_b32 v14, 1, v12
    v_lshlrev_b32 v14, 1, v14
    v_lshrrev_b32 v17, 1, v12
    v_or_b32 v14, v14, v17
    v_cmp_eq_u32 vcc, 4, v12
    s_nop 1
    v_cndmask_b32 v14, v14, v12, vcc
    v_lshlrev_b32 v14, 10, v14
    v_add3_u32 v14, v14, v11, v8
    v_add_u32 v10, 4, v9
    v_mul_lo_u32 v11, v10, s28
    v_lshrrev_b32 v11, 18, v11
    v_mul_u32_u24 v12, 5, v11
    v_sub_u32 v12, v10, v12
    v_mul_lo_u32 v11, v11, s29
    v_and_b32 v15, 1, v12
    v_lshlrev_b32 v15, 1, v15
    v_lshrrev_b32 v17, 1, v12
    v_or_b32 v15, v15, v17
    v_cmp_eq_u32 vcc, 4, v12
    s_nop 1
    v_cndmask_b32 v15, v15, v12, vcc
    v_lshlrev_b32 v15, 10, v15
    v_add3_u32 v15, v15, v11, v8
    v_add_u32 v10, 6, v9
    v_mul_lo_u32 v11, v10, s28
    v_lshrrev_b32 v11, 18, v11
    v_mul_u32_u24 v12, 5, v11
    v_sub_u32 v12, v10, v12
    v_mul_lo_u32 v11, v11, s29
    v_and_b32 v16, 1, v12
    v_lshlrev_b32 v16, 1, v16
    v_lshrrev_b32 v17, 1, v12
    v_or_b32 v16, v16, v17
    v_cmp_eq_u32 vcc, 4, v12
    s_nop 1
    v_cndmask_b32 v16, v16, v12, vcc
    v_lshlrev_b32 v16, 10, v16
    v_add3_u32 v16, v16, v11, v8
    v_mul_f32 v32, s23, v32
    v_mul_f32 v33, s23, v33
    v_mul_f32 v34, s23, v34
    v_mul_f32 v35, s23, v35
    v_cvt_pk_bf16_f32 v64, v32, v33
    v_cvt_pk_bf16_f32 v65, v34, v35
    buffer_store_dwordx2 v[64:65], v13, s[12:15], s27 offen offset:0 sc1
    v_mul_f32 v36, s23, v36
    v_mul_f32 v37, s23, v37
    v_mul_f32 v38, s23, v38
    v_mul_f32 v39, s23, v39
    v_cvt_pk_bf16_f32 v66, v36, v37
    v_cvt_pk_bf16_f32 v67, v38, v39
    buffer_store_dwordx2 v[66:67], v14, s[12:15], s27 offen offset:0 sc1
    v_mul_f32 v40, s23, v40
    v_mul_f32 v41, s23, v41
    v_mul_f32 v42, s23, v42
    v_mul_f32 v43, s23, v43
    v_cvt_pk_bf16_f32 v64, v40, v41
    v_cvt_pk_bf16_f32 v65, v42, v43
    buffer_store_dwordx2 v[64:65], v15, s[12:15], s27 offen offset:0 sc1
    v_mul_f32 v44, s23, v44
    v_mul_f32 v45, s23, v45
    v_mul_f32 v46, s23, v46
    v_mul_f32 v47, s23, v47
    v_cvt_pk_bf16_f32 v66, v44, v45
    v_cvt_pk_bf16_f32 v67, v46, v47
    buffer_store_dwordx2 v[66:67], v16, s[12:15], s27 offen offset:0 sc1
    v_mul_f32 v48, s23, v48
    v_mul_f32 v49, s23, v49
    v_mul_f32 v50, s23, v50
    v_mul_f32 v51, s23, v51
    v_cvt_pk_bf16_f32 v68, v48, v49
    v_cvt_pk_bf16_f32 v69, v50, v51
    buffer_store_dwordx2 v[68:69], v13, s[12:15], s27 offen offset:256 sc1
    v_mul_f32 v52, s23, v52
    v_mul_f32 v53, s23, v53
    v_mul_f32 v54, s23, v54
    v_mul_f32 v55, s23, v55
    v_cvt_pk_bf16_f32 v70, v52, v53
    v_cvt_pk_bf16_f32 v71, v54, v55
    buffer_store_dwordx2 v[70:71], v14, s[12:15], s27 offen offset:256 sc1
    v_mul_f32 v56, s23, v56
    v_mul_f32 v57, s23, v57
    v_mul_f32 v58, s23, v58
    v_mul_f32 v59, s23, v59
    v_cvt_pk_bf16_f32 v68, v56, v57
    v_cvt_pk_bf16_f32 v69, v58, v59
    buffer_store_dwordx2 v[68:69], v15, s[12:15], s27 offen offset:256 sc1
    v_mul_f32 v60, s23, v60
    v_mul_f32 v61, s23, v61
    v_mul_f32 v62, s23, v62
    v_mul_f32 v63, s23, v63
    v_cvt_pk_bf16_f32 v70, v60, v61
    v_cvt_pk_bf16_f32 v71, v62, v63
    buffer_store_dwordx2 v[70:71], v16, s[12:15], s27 offen offset:256 sc1
    s_branch q_fin
q_vpart:
    s_waitcnt vmcnt(4)
    s_barrier
    ds_read_b128 v[64:67], v88 offset:0
    ds_read_b128 v[68:71], v88 offset:4096
    ds_read_b64_tr_b16 v[72:73], v100 offset:32768
    ds_read_b64_tr_b16 v[74:75], v100 offset:33792
    ds_read_b128 v[76:79], v89 offset:0
    ds_read_b128 v[80:83], v89 offset:4096
    ds_read_b64_tr_b16 v[84:85], v100 offset:36864
    ds_read_b64_tr_b16 v[86:87], v100 offset:37888
    s_waitcnt lgkmcnt(4)
    v_mfma_f32_32x32x16_bf16 v[32:47], v[64:67], v[72:75], v[32:47]
    v_mfma_f32_32x32x16_bf16 v[48:63], v[68:71], v[72:75], v[48:63]
    s_add_u32 s22, s20, s35
    s_add_u32 m0, s30, 73728
    s_add_u32 s35, s35, 122880
    buffer_load_dwordx4 v5, s[8:11], s22 offen lds
    s_cmp_eq_u32 s35, 2457600
    s_cselect_b32 s35, 0, s35
    s_add_u32 s22, s19, s34
    s_add_u32 m0, s21, 32768
    s_add_u32 s34, s34, 128
    buffer_load_dwordx4 v2, s[4:7], s22 offen lds
    s_add_u32 m0, s21, 33792
    s_cmp_eq_u32 s34, 1280
    buffer_load_dwordx4 v3, s[4:7], s22 offen lds
    s_cselect_b32 s34, 0, s34
    s_waitcnt lgkmcnt(0)
    v_mfma_f32_32x32x16_bf16 v[32:47], v[76:79], v[84:87], v[32:47]
    v_mfma_f32_32x32x16_bf16 v[48:63], v[80:83], v[84:87], v[48:63]
    s_add_u32 s60, s60, 0x9e3779b9
    s_waitcnt vmcnt(6)
    s_barrier
    ds_read_b128 v[64:67], v90 offset:0
    ds_read_b128 v[68:71], v90 offset:4096
    ds_read_b64_tr_b16 v[72:73], v100 offset:40960
    ds_read_b64_tr_b16 v[74:75], v100 offset:41984
    ds_read_b128 v[76:79], v91 offset:0
    ds_read_b128 v[80:83], v91 offset:4096
    ds_read_b64_tr_b16 v[84:85], v100 offset:45056
    ds_read_b64_tr_b16 v[86:87], v100 offset:46080
    s_waitcnt lgkmcnt(4)
    v_mfma_f32_32x32x16_bf16 v[32:47], v[64:67], v[72:75], v[32:47]
    v_mfma_f32_32x32x16_bf16 v[48:63], v[68:71], v[72:75], v[48:63]
    s_add_u32 s22, s20, s35
    s_add_u32 m0, s30, 49152
    s_add_u32 s35, s35, 122880
    buffer_load_dwordx4 v5, s[8:11], s22 offen lds
    s_cmp_eq_u32 s35, 2457600
    s_cselect_b32 s35, 0, s35
    s_waitcnt lgkmcnt(0)
    v_mfma_f32_32x32x16_bf16 v[32:47], v[76:79], v[84:87], v[32:47]
    v_mfma_f32_32x32x16_bf16 v[48:63], v[80:83], v[84:87], v[48:63]
    s_waitcnt vmcnt(4)
    s_barrier
    ds_read_b128 v[64:67], v88 offset:16384
    ds_read_b128 v[68:71], v88 offset:20480
    ds_read_b64_tr_b16 v[72:73], v100 offset:49152
    ds_read_b64_tr_b16 v[74:75], v100 offset:50176
    ds_read_b128 v[76:79], v89 offset:16384
    ds_read_b128 v[80:83], v89 offset:20480
    ds_read_b64_tr_b16 v[84:85], v100 offset:53248
    ds_read_b64_tr_b16 v[86:87], v100 offset:54272
    s_waitcnt lgkmcnt(4)
    v_mfma_f32_32x32x16_bf16 v[32:47], v[64:67], v[72:75], v[32:47]
    v_mfma_f32_32x32x16_bf16 v[48:63], v[68:71], v[72:75], v[48:63]
    s_add_u32 s22, s20, s35
    s_add_u32 m0, s30, 57344
    s_add_u32 s35, s35, 122880
    buffer_load_dwordx4 v5, s[8:11], s22 offen lds
    s_cmp_eq_u32 s35, 2457600
    s_cselect_b32 s35, 0, s35
    s_add_u32 s22, s19, s34
    s_add_u32 m0, s21, 0
    s_add_u32 s34, s34, 128
    buffer_load_dwordx4 v2, s[4:7], s22 offen lds
    s_add_u32 m0, s21, 1024
    s_cmp_eq_u32 s34, 1280
    buffer_load_dwordx4 v3, s[4:7], s22 offen lds
    s_cselect_b32 s34, 0, s34
    s_waitcnt lgkmcnt(0)
    v_mfma_f32_32x32x16_bf16 v[32:47], v[76:79], v[84:87], v[32:47]
    v_mfma_f32_32x32x16_bf16 v[48:63], v[80:83], v[84:87], v[48:63]
    s_waitcnt vmcnt(6)
    s_barrier
    ds_read_b128 v[64:67], v90 offset:16384
    ds_read_b128 v[68:71], v90 offset:20480
    ds_read_b64_tr_b16 v[72:73], v100 offset:57344
    ds_read_b64_tr_b16 v[74:75], v100 offset:58368
    ds_read_b128 v[76:79], v91 offset:16384
    ds_read_b128 v[80:83], v91 offset:20480
    ds_read_b64_tr_b16 v[84:85], v100 offset:61440
    ds_read_b64_tr_b16 v[86:87], v100 offset:62464
    s_waitcnt lgkmcnt(4)
    v_mfma_f32_32x32x16_bf16 v[32:47], v[64:67], v[72:75], v[32:47]
    v_mfma_f32_32x32x16_bf16 v[48:63], v[68:71], v[72:75], v[48:63]
    s_add_u32 s22, s20, s35
    s_add_u32 m0, s30, 65536
    s_add_u32 s35, s35, 122880
    buffer_load_dwordx4 v5, s[8:11], s22 offen lds
    s_cmp_eq_u32 s35, 2457600
    s_cselect_b32 s35, 0, s35
    s_waitcnt lgkmcnt(0)
    v_mfma_f32_32x32x16_bf16 v[32:47], v[76:79], v[84:87], v[32:47]
    v_mfma_f32_32x32x16_bf16 v[48:63], v[80:83], v[84:87], v[48:63]
    s_waitcnt vmcnt(4)
    s_barrier
    ds_read_b128 v[64:67], v88 offset:32768
    ds_read_b128 v[68:71], v88 offset:36864
    ds_read_b64_tr_b16 v[72:73], v100 offset:32768
    ds_read_b64_tr_b16 v[74:75], v100 offset:33792
    ds_read_b128 v[76:79], v89 offset:32768
    ds_read_b128 v[80:83], v89 offset:36864
    ds_read_b64_tr_b16 v[84:85], v100 offset:36864
    ds_read_b64_tr_b16 v[86:87], v100 offset:37888
    s_waitcnt lgkmcnt(4)
    v_mfma_f32_32x32x16_bf16 v[32:47], v[64:67], v[72:75], v[32:47]
    v_mfma_f32_32x32x16_bf16 v[48:63], v[68:71], v[72:75], v[48:63]
    s_add_u32 s22, s20, s35
    s_add_u32 m0, s30, 73728
    s_add_u32 s35, s35, 122880
    buffer_load_dwordx4 v5, s[8:11], s22 offen lds
    s_cmp_eq_u32 s35, 2457600
    s_cselect_b32 s35, 0, s35
    s_add_u32 s22, s19, s34
    s_add_u32 m0, s21, 16384
    s_add_u32 s34, s34, 128
    buffer_load_dwordx4 v2, s[4:7], s22 offen lds
    s_add_u32 m0, s21, 17408
    s_cmp_eq_u32 s34, 1280
    buffer_load_dwordx4 v3, s[4:7], s22 offen lds
    s_cselect_b32 s34, 0, s34
    s_waitcnt lgkmcnt(0)
    v_mfma_f32_32x32x16_bf16 v[32:47], v[76:79], v[84:87], v[32:47]
    v_mfma_f32_32x32x16_bf16 v[48:63], v[80:83], v[84:87], v[48:63]
    s_waitcnt vmcnt(6)
    s_barrier
    ds_read_b128 v[64:67], v90 offset:32768
    ds_read_b128 v[68:71], v90 offset:36864
    ds_read_b64_tr_b16 v[72:73], v100 offset:40960
    ds_read_b64_tr_b16 v[74:75], v100 offset:41984
    ds_read_b128 v[76:79], v91 offset:32768
    ds_read_b128 v[80:83], v91 offset:36864
    ds_read_b64_tr_b16 v[84:85], v100 offset:45056
    ds_read_b64_tr_b16 v[86:87], v100 offset:46080
    s_waitcnt lgkmcnt(4)
    v_mfma_f32_32x32x16_bf16 v[32:47], v[64:67], v[72:75], v[32:47]
    v_mfma_f32_32x32x16_bf16 v[48:63], v[68:71], v[72:75], v[48:63]
    s_add_u32 s22, s20, s35
    s_add_u32 m0, s30, 49152
    s_add_u32 s35, s35, 122880
    buffer_load_dwordx4 v5, s[8:11], s22 offen lds
    s_cmp_eq_u32 s35, 2457600
    s_cselect_b32 s35, 0, s35
    s_waitcnt lgkmcnt(0)
    v_mfma_f32_32x32x16_bf16 v[32:47], v[76:79], v[84:87], v[32:47]
    v_mfma_f32_32x32x16_bf16 v[48:63], v[80:83], v[84:87], v[48:63]
    s_waitcnt vmcnt(4)
    s_barrier
    ds_read_b128 v[64:67], v88 offset:0
    ds_read_b128 v[68:71], v88 offset:4096
    ds_read_b64_tr_b16 v[72:73], v100 offset:49152
    ds_read_b64_tr_b16 v[74:75], v100 offset:50176
    ds_read_b128 v[76:79], v89 offset:0
    ds_read_b128 v[80:83], v89 offset:4096
    ds_read_b64_tr_b16 v[84:85], v100 offset:53248
    ds_read_b64_tr_b16 v[86:87], v100 offset:54272
    s_waitcnt lgkmcnt(4)
    v_mfma_f32_32x32x16_bf16 v[32:47], v[64:67], v[72:75], v[32:47]
    v_mfma_f32_32x32x16_bf16 v[48:63], v[68:71], v[72:75], v[48:63]
    s_add_u32 s22, s20, s35
    s_add_u32 m0, s30, 57344
    s_add_u32 s35, s35, 122880
    buffer_load_dwordx4 v5, s[8:11], s22 offen lds
    s_cmp_eq_u32 s35, 2457600
    s_cselect_b32 s35, 0, s35
    s_add_u32 s22, s19, s34
    s_add_u32 m0, s21, 32768
    s_add_u32 s34, s34, 128
    buffer_load_dwordx4 v2, s[4:7], s22 offen lds
    s_add_u32 m0, s21, 33792
    s_cmp_eq_u32 s34, 1280
    buffer_load_dwordx4 v3, s[4:7], s22 offen lds
    s_cselect_b32 s34, 0, s34
    s_waitcnt lgkmcnt(0)
    v_mfma_f32_32x32x16_bf16 v[32:47], v[76:79], v[84:87], v[32:47]
    v_mfma_f32_32x32x16_bf16 v[48:63], v[80:83], v[84:87], v[48:63]
    s_waitcnt vmcnt(6)
    s_barrier
    ds_read_b128 v[64:67], v90 offset:0
    ds_read_b128 v[68:71], v90 offset:4096
    ds_read_b64_tr_b16 v[72:73], v100 offset:57344
    ds_read_b64_tr_b16 v[74:75], v100 offset:58368
    ds_read_b128 v[76:79], v91 offset:0
    ds_read_b128 v[80:83], v91 offset:4096
    ds_read_b64_tr_b16 v[84:85], v100 offset:61440
    ds_read_b64_tr_b16 v[86:87], v100 offset:62464
    s_waitcnt lgkmcnt(4)
    v_mfma_f32_32x32x16_bf16 v[32:47], v[64:67], v[72:75], v[32:47]
    v_mfma_f32_32x32x16_bf16 v[48:63], v[68:71], v[72:75], v[48:63]
    s_add_u32 s22, s20, s35
    s_add_u32 m0, s30, 65536
    s_add_u32 s35, s35, 122880
    buffer_load_dwordx4 v5, s[8:11], s22 offen lds
    s_cmp_eq_u32 s35, 2457600
    s_cselect_b32 s35, 0, s35
    s_waitcnt lgkmcnt(0)
    v_mfma_f32_32x32x16_bf16 v[32:47], v[76:79], v[84:87], v[32:47]
    v_mfma_f32_32x32x16_bf16 v[48:63], v[80:83], v[84:87], v[48:63]
    s_waitcnt vmcnt(4)
    s_barrier
    ds_read_b128 v[64:67], v88 offset:16384
    ds_read_b128 v[68:71], v88 offset:20480
    ds_read_b64_tr_b16 v[72:73], v100 offset:32768
    ds_read_b64_tr_b16 v[74:75], v100 offset:33792
    ds_read_b128 v[76:79], v89 offset:16384
    ds_read_b128 v[80:83], v89 offset:20480
    ds_read_b64_tr_b16 v[84:85], v100 offset:36864
    ds_read_b64_tr_b16 v[86:87], v100 offset:37888
    s_waitcnt lgkmcnt(4)
    v_mfma_f32_32x32x16_bf16 v[32:47], v[64:67], v[72:75], v[32:47]
    v_mfma_f32_32x32x16_bf16 v[48:63], v[68:71], v[72:75], v[48:63]
    s_add_u32 s22, s20, s35
    s_add_u32 m0, s30, 73728
    s_add_u32 s35, s35, 122880
    buffer_load_dwordx4 v5, s[8:11], s22 offen lds
    s_cmp_eq_u32 s35, 2457600
    s_cselect_b32 s35, 0, s35
    s_add_u32 s22, s19, s34
    s_add_u32 m0, s21, 0
    s_add_u32 s34, s34, 128
    buffer_load_dwordx4 v2, s[4:7], s22 offen lds
    s_add_u32 m0, s21, 1024
    s_cmp_eq_u32 s34, 1280
    buffer_load_dwordx4 v3, s[4:7], s22 offen lds
    s_cselect_b32 s34, 0, s34
    s_waitcnt lgkmcnt(0)
    v_mfma_f32_32x32x16_bf16 v[32:47], v[76:79], v[84:87], v[32:47]
    v_mfma_f32_32x32x16_bf16 v[48:63], v[80:83], v[84:87], v[48:63]
    s_waitcnt vmcnt(6)
    s_barrier
    ds_read_b128 v[64:67], v90 offset:16384
    ds_read_b128 v[68:71], v90 offset:20480
    ds_read_b64_tr_b16 v[72:73], v100 offset:40960
    ds_read_b64_tr_b16 v[74:75], v100 offset:41984
    ds_read_b128 v[76:79], v91 offset:16384
    ds_read_b128 v[80:83], v91 offset:20480
    ds_read_b64_tr_b16 v[84:85], v100 offset:45056
    ds_read_b64_tr_b16 v[86:87], v100 offset:46080
    s_waitcnt lgkmcnt(4)
    v_mfma_f32_32x32x16_bf16 v[32:47], v[64:67], v[72:75], v[32:47]
    v_mfma_f32_32x32x16_bf16 v[48:63], v[68:71], v[72:75], v[48:63]
    s_add_u32 s22, s20, s35
    s_add_u32 m0, s30, 49152
    s_add_u32 s35, s35, 122880
    buffer_load_dwordx4 v5, s[8:11], s22 offen lds
    s_cmp_eq_u32 s35, 2457600
    s_cselect_b32 s35, 0, s35
    s_waitcnt lgkmcnt(0)
    v_mfma_f32_32x32x16_bf16 v[32:47], v[76:79], v[84:87], v[32:47]
    v_mfma_f32_32x32x16_bf16 v[48:63], v[80:83], v[84:87], v[48:63]
    s_waitcnt vmcnt(4)
    s_barrier
    ds_read_b128 v[64:67], v88 offset:32768
    ds_read_b128 v[68:71], v88 offset:36864
    ds_read_b64_tr_b16 v[72:73], v100 offset:49152
    ds_read_b64_tr_b16 v[74:75], v100 offset:50176
    ds_read_b128 v[76:79], v89 offset:32768
    ds_read_b128 v[80:83], v89 offset:36864
    ds_read_b64_tr_b16 v[84:85], v100 offset:53248
    ds_read_b64_tr_b16 v[86:87], v100 offset:54272
    s_waitcnt lgkmcnt(4)
    v_mfma_f32_32x32x16_bf16 v[32:47], v[64:67], v[72:75], v[32:47]
    v_mfma_f32_32x32x16_bf16 v[48:63], v[68:71], v[72:75], v[48:63]
    s_add_u32 s22, s20, s35
    s_add_u32 m0, s30, 57344
    s_add_u32 s35, s35, 122880
    buffer_load_dwordx4 v5, s[8:11], s22 offen lds
    s_cmp_eq_u32 s35, 2457600
    s_cselect_b32 s35, 0, s35
    s_add_u32 s22, s19, s34
    s_add_u32 m0, s21, 16384
    s_add_u32 s34, s34, 128
    buffer_load_dwordx4 v2, s[4:7], s22 offen lds
    s_add_u32 m0, s21, 17408
    s_cmp_eq_u32 s34, 1280
    buffer_load_dwordx4 v3, s[4:7], s22 offen lds
    s_cselect_b32 s34, 0, s34
    s_waitcnt lgkmcnt(0)
    v_mfma_f32_32x32x16_bf16 v[32:47], v[76:79], v[84:87], v[32:47]
    v_mfma_f32_32x32x16_bf16 v[48:63], v[80:83], v[84:87], v[48:63]
    s_waitcnt vmcnt(6)
    s_barrier
    ds_read_b128 v[64:67], v90 offset:32768
    ds_read_b128 v[68:71], v90 offset:36864
    ds_read_b64_tr_b16 v[72:73], v100 offset:57344
    ds_read_b64_tr_b16 v[74:75], v100 offset:58368
    ds_read_b128 v[76:79], v91 offset:32768
    ds_read_b128 v[80:83], v91 offset:36864
    ds_read_b64_tr_b16 v[84:85], v100 offset:61440
    ds_read_b64_tr_b16 v[86:87], v100 offset:62464
    s_waitcnt lgkmcnt(4)
    v_mfma_f32_32x32x16_bf16 v[32:47], v[64:67], v[72:75], v[32:47]
    v_mfma_f32_32x32x16_bf16 v[48:63], v[68:71], v[72:75], v[48:63]
    s_add_u32 s22, s20, s35
    s_add_u32 m0, s30, 65536
    s_add_u32 s35, s35, 122880
    buffer_load_dwordx4 v5, s[8:11], s22 offen lds
    s_cmp_eq_u32 s35, 2457600
    s_cselect_b32 s35, 0, s35
    s_waitcnt lgkmcnt(0)
    v_mfma_f32_32x32x16_bf16 v[32:47], v[76:79], v[84:87], v[32:47]
    v_mfma_f32_32x32x16_bf16 v[48:63], v[80:83], v[84:87], v[48:63]
    s_waitcnt vmcnt(4)
    s_barrier
    ds_read_b128 v[64:67], v88 offset:0
    ds_read_b128 v[68:71], v88 offset:4096
    ds_read_b64_tr_b16 v[72:73], v100 offset:32768
    ds_read_b64_tr_b16 v[74:75], v100 offset:33792
    ds_read_b128 v[76:79], v89 offset:0
    ds_read_b128 v[80:83], v89 offset:4096
    ds_read_b64_tr_b16 v[84:85], v100 offset:36864
    ds_read_b64_tr_b16 v[86:87], v100 offset:37888
    s_waitcnt lgkmcnt(4)
    v_mfma_f32_32x32x16_bf16 v[32:47], v[64:67], v[72:75], v[32:47]
    v_mfma_f32_32x32x16_bf16 v[48:63], v[68:71], v[72:75], v[48:63]
    s_add_u32 s22, s20, s35
    s_add_u32 m0, s30, 73728
    s_add_u32 s35, s35, 122880
    buffer_load_dwordx4 v5, s[8:11], s22 offen lds
    s_cmp_eq_u32 s35, 2457600
    s_cselect_b32 s35, 0, s35
    s_add_u32 s22, s19, s34
    s_add_u32 m0, s21, 32768
    s_add_u32 s34, s34, 128
    buffer_load_dwordx4 v2, s[4:7], s22 offen lds
    s_add_u32 m0, s21, 33792
    s_cmp_eq_u32 s34, 1280
    buffer_load_dwordx4 v3, s[4:7], s22 offen lds
    s_cselect_b32 s34, 0, s34
    s_waitcnt lgkmcnt(0)
    v_mfma_f32_32x32x16_bf16 v[32:47], v[76:79], v[84:87], v[32:47]
    v_mfma_f32_32x32x16_bf16 v[48:63], v[80:83], v[84:87], v[48:63]
    s_waitcnt vmcnt(6)
    s_barrier
    ds_read_b128 v[64:67], v90 offset:0
    ds_read_b128 v[68:71], v90 offset:4096
    ds_read_b64_tr_b16 v[72:73], v100 offset:40960
    ds_read_b64_tr_b16 v[74:75], v100 offset:41984
    ds_read_b128 v[76:79], v91 offset:0
    ds_read_b128 v[80:83], v91 offset:4096
    ds_read_b64_tr_b16 v[84:85], v100 offset:45056
    ds_read_b64_tr_b16 v[86:87], v100 offset:46080
    s_waitcnt lgkmcnt(4)
    v_mfma_f32_32x32x16_bf16 v[32:47], v[64:67], v[72:75], v[32:47]
    v_mfma_f32_32x32x16_bf16 v[48:63], v[68:71], v[72:75], v[48:63]
    s_add_u32 s22, s20, s35
    s_add_u32 m0, s30, 49152
    s_add_u32 s35, s35, 122880
    buffer_load_dwordx4 v5, s[8:11], s22 offen lds
    s_cmp_eq_u32 s35, 2457600
    s_cselect_b32 s35, 0, s35
    s_waitcnt lgkmcnt(0)
    v_mfma_f32_32x32x16_bf16 v[32:47], v[76:79], v[84:87], v[32:47]
    v_mfma_f32_32x32x16_bf16 v[48:63], v[80:83], v[84:87], v[48:63]
    s_waitcnt vmcnt(4)
    s_barrier
    ds_read_b128 v[64:67], v88 offset:16384
    ds_read_b128 v[68:71], v88 offset:20480
    ds_read_b64_tr_b16 v[72:73], v100 offset:49152
    ds_read_b64_tr_b16 v[74:75], v100 offset:50176
    ds_read_b128 v[76:79], v89 offset:16384
    ds_read_b128 v[80:83], v89 offset:20480
    ds_read_b64_tr_b16 v[84:85], v100 offset:53248
    ds_read_b64_tr_b16 v[86:87], v100 offset:54272
    s_waitcnt lgkmcnt(4)
    v_mfma_f32_32x32x16_bf16 v[32:47], v[64:67], v[72:75], v[32:47]
    v_mfma_f32_32x32x16_bf16 v[48:63], v[68:71], v[72:75], v[48:63]
    s_add_u32 s22, s20, s35
    s_add_u32 m0, s30, 57344
    s_add_u32 s35, s35, 122880
    buffer_load_dwordx4 v5, s[8:11], s22 offen lds
    s_cmp_eq_u32 s35, 2457600
    s_cselect_b32 s35, 0, s35
    s_add_u32 s22, s19, s34
    s_add_u32 m0, s21, 0
    s_add_u32 s34, s34, 128
    buffer_load_dwordx4 v2, s[4:7], s22 offen lds
    s_add_u32 m0, s21, 1024
    s_cmp_eq_u32 s34, 1280
    buffer_load_dwordx4 v3, s[4:7], s22 offen lds
    s_cselect_b32 s34, 0, s34
    s_waitcnt lgkmcnt(0)
    v_mfma_f32_32x32x16_bf16 v[32:47], v[76:79], v[84:87], v[32:47]
    v_mfma_f32_32x32x16_bf16 v[48:63], v[80:83], v[84:87], v[48:63]
    s_waitcnt vmcnt(6)
    s_barrier
    ds_read_b128 v[64:67], v90 offset:16384
    ds_read_b128 v[68:71], v90 offset:20480
    ds_read_b64_tr_b16 v[72:73], v100 offset:57344
    ds_read_b64_tr_b16 v[74:75], v100 offset:58368
    ds_read_b128 v[76:79], v91 offset:16384
    ds_read_b128 v[80:83], v91 offset:20480
    ds_read_b64_tr_b16 v[84:85], v100 offset:61440
    ds_read_b64_tr_b16 v[86:87], v100 offset:62464
    s_waitcnt lgkmcnt(4)
    v_mfma_f32_32x32x16_bf16 v[32:47], v[64:67], v[72:75], v[32:47]
    v_mfma_f32_32x32x16_bf16 v[48:63], v[68:71], v[72:75], v[48:63]
    s_add_u32 s22, s20, s35
    s_add_u32 m0, s30, 65536
    s_add_u32 s35, s35, 122880
    buffer_load_dwordx4 v5, s[8:11], s22 offen lds
    s_cmp_eq_u32 s35, 2457600
    s_cselect_b32 s35, 0, s35
    s_waitcnt lgkmcnt(0)
    v_mfma_f32_32x32x16_bf16 v[32:47], v[76:79], v[84:87], v[32:47]
    v_mfma_f32_32x32x16_bf16 v[48:63], v[80:83], v[84:87], v[48:63]
    s_waitcnt vmcnt(4)
    s_barrier
    ds_read_b128 v[64:67], v88 offset:32768
    ds_read_b128 v[68:71], v88 offset:36864
    ds_read_b64_tr_b16 v[72:73], v100 offset:32768
    ds_read_b64_tr_b16 v[74:75], v100 offset:33792
    ds_read_b128 v[76:79], v89 offset:32768
    ds_read_b128 v[80:83], v89 offset:36864
    ds_read_b64_tr_b16 v[84:85], v100 offset:36864
    ds_read_b64_tr_b16 v[86:87], v100 offset:37888
    s_waitcnt lgkmcnt(4)
    v_mfma_f32_32x32x16_bf16 v[32:47], v[64:67], v[72:75], v[32:47]
    v_mfma_f32_32x32x16_bf16 v[48:63], v[68:71], v[72:75], v[48:63]
    s_add_u32 s22, s20, s35
    s_add_u32 m0, s30, 73728
    s_add_u32 s35, s35, 122880
    buffer_load_dwordx4 v5, s[8:11], s22 offen lds
    s_cmp_eq_u32 s35, 2457600
    s_cselect_b32 s35, 0, s35
    s_waitcnt lgkmcnt(0)
    v_mfma_f32_32x32x16_bf16 v[32:47], v[76:79], v[84:87], v[32:47]
    v_mfma_f32_32x32x16_bf16 v[48:63], v[80:83], v[84:87], v[48:63]
    s_waitcnt vmcnt(4)
    s_barrier
    ds_read_b128 v[64:67], v90 offset:32768
    ds_read_b128 v[68:71], v90 offset:36864
    ds_read_b64_tr_b16 v[72:73], v100 offset:40960
    ds_read_b64_tr_b16 v[74:75], v100 offset:41984
    ds_read_b128 v[76:79], v91 offset:32768
    ds_read_b128 v[80:83], v91 offset:36864
    ds_read_b64_tr_b16 v[84:85], v100 offset:45056
    ds_read_b64_tr_b16 v[86:87], v100 offset:46080
    s_waitcnt lgkmcnt(4)
    v_mfma_f32_32x32x16_bf16 v[32:47], v[64:67], v[72:75], v[32:47]
    v_mfma_f32_32x32x16_bf16 v[48:63], v[68:71], v[72:75], v[48:63]
    s_waitcnt lgkmcnt(0)
    v_mfma_f32_32x32x16_bf16 v[32:47], v[76:79], v[84:87], v[32:47]
    v_mfma_f32_32x32x16_bf16 v[48:63], v[80:83], v[84:87], v[48:63]
    s_waitcnt vmcnt(1)
    s_barrier
    ds_read_b128 v[64:67], v88 offset:0
    ds_read_b128 v[68:71], v88 offset:4096
    ds_read_b64_tr_b16 v[72:73], v100 offset:49152
    ds_read_b64_tr_b16 v[74:75], v100 offset:50176
    ds_read_b128 v[76:79], v89 offset:0
    ds_read_b128 v[80:83], v89 offset:4096
    ds_read_b64_tr_b16 v[84:85], v100 offset:53248
    ds_read_b64_tr_b16 v[86:87], v100 offset:54272
    s_waitcnt lgkmcnt(4)
    v_mfma_f32_32x32x16_bf16 v[32:47], v[64:67], v[72:75], v[32:47]
    v_mfma_f32_32x32x16_bf16 v[48:63], v[68:71], v[72:75], v[48:63]
    s_waitcnt lgkmcnt(0)
    v_mfma_f32_32x32x16_bf16 v[32:47], v[76:79], v[84:87], v[32:47]
    v_mfma_f32_32x32x16_bf16 v[48:63], v[80:83], v[84:87], v[48:63]
    s_waitcnt vmcnt(0)
    s_barrier
    ds_read_b128 v[64:67], v90 offset:0
    ds_read_b128 v[68:71], v90 offset:4096
    ds_read_b64_tr_b16 v[72:73], v100 offset:57344
    ds_read_b64_tr_b16 v[74:75], v100 offset:58368
    ds_read_b128 v[76:79], v91 offset:0
    ds_read_b128 v[80:83], v91 offset:4096
    ds_read_b64_tr_b16 v[84:85], v100 offset:61440
    ds_read_b64_tr_b16 v[86:87], v100 offset:62464
    s_waitcnt lgkmcnt(4)
    v_mfma_f32_32x32x16_bf16 v[32:47], v[64:67], v[72:75], v[32:47]
    v_mfma_f32_32x32x16_bf16 v[48:63], v[68:71], v[72:75], v[48:63]
    s_waitcnt lgkmcnt(0)
    v_mfma_f32_32x32x16_bf16 v[32:47], v[76:79], v[84:87], v[32:47]
    v_mfma_f32_32x32x16_bf16 v[48:63], v[80:83], v[84:87], v[48:63]
    s_sub_u32 s25, s18, 10
    s_lshl_b32 s25, s25, 7
    s_lshr_b32 s26, s16, 1
    s_lshl_b32 s26, s26, 5
    s_add_u32 s25, s25, s26
    s_and_b32 s26, s16, 1
    s_lshl_b32 s26, s26, 1
    s_lshl_b32 s27, s17, 2
    s_add_u32 s27, s27, s26
    s_mul_i32 s27, s27, 1536
    s_add_u32 s27, s27, 5242880
    v_and_b32 v8, 31, v1
    v_add_u32 v8, s25, v8
    s_mov_b32 s28, 52429
    v_mul_lo_u32 v9, v8, s28
    v_lshrrev_b32 v9, 20, v9
    v_mul_u32_u24 v10, 20, v9
    v_sub_u32 v10, v8, v10
    s_mov_b32 s29, 98304
    v_mul_lo_u32 v9, v9, s29
    v_lshrrev_b32 v11, 5, v1
    v_mul_u32_u24 v11, 384, v11
    v_add_u32 v9, v9, v11
    v_lshlrev_b32 v11, 4, v10
    v_add_u32 v12, v9, v11
    v_add3_u32 v13, v9, v11, 0
    v_add_u32 v13, 320, v13
    v_cmp_eq_u32 vcc, 0, v10
    v_mov_b32 v14, 0x3f803f80
    s_nop 0
    v_cndmask_b32 v16, 0, v14, vcc
    v_cndmask_b32 v17, 0, v14, vcc
    v_cndmask_b32 v18, 0, v14, vcc
    v_cndmask_b32 v19, 0, v14, vcc
    v_cmp_gt_u32 s[30:31], 4, v10
    v_cvt_pk_bf16_f32 v64, v32, v33
    v_cvt_pk_bf16_f32 v65, v34, v35
    v_cvt_pk_bf16_f32 v66, v36, v37
    v_cvt_pk_bf16_f32 v67, v38, v39
    buffer_store_dwordx4 v[64:67], v12, s[12:15], s27 offen offset:0 sc1
    v_cvt_pk_bf16_f32 v68, v40, v41
    v_cvt_pk_bf16_f32 v69, v42, v43
    v_cvt_pk_bf16_f32 v70, v44, v45
    v_cvt_pk_bf16_f32 v71, v46, v47
    buffer_store_dwordx4 v[68:71], v12, s[12:15], s27 offen offset:768 sc1
    v_cvt_pk_bf16_f32 v64, v48, v49
    v_cvt_pk_bf16_f32 v65, v50, v51
    v_cvt_pk_bf16_f32 v66, v52, v53
    v_cvt_pk_bf16_f32 v67, v54, v55
    buffer_store_dwordx4 v[64:67], v12, s[12:15], s27 offen offset:1536 sc1
    v_cvt_pk_bf16_f32 v68, v56, v57
    v_cvt_pk_bf16_f32 v69, v58, v59
    v_cvt_pk_bf16_f32 v70, v60, v61
    v_cvt_pk_bf16_f32 v71, v62, v63
    buffer_store_dwordx4 v[68:71], v12, s[12:15], s27 offen offset:2304 sc1
    s_and_saveexec_b64 s[32:33], s[30:31]
    s_cbranch_execz q_vdone
    buffer_store_dwordx4 v[16:19], v13, s[12:15], s27 offen offset:0 sc1
    buffer_store_dwordx4 v[16:19], v13, s[12:15], s27 offen offset:768 sc1
    buffer_store_dwordx4 v[16:19], v13, s[12:15], s27 offen offset:1536 sc1
    buffer_store_dwordx4 v[16:19], v13, s[12:15], s27 offen offset:2304 sc1
q_vdone:
    s_mov_b64 exec, -1
    s_branch q_fin
q_gate:
    s_waitcnt lgkmcnt(0)
    s_mov_b32 s61, 18972672
    s_load_dword s60, s[58:59], s61
    s_load_dwordx2 s[8:9], s[0:1], 56
    s_mov_b32 s10, 1280
    s_mov_b32 s11, 0x20000
    s_lshl_b32 s22, s17, 7
    s_lshl_b32 s23, s16, 4
    s_add_u32 s22, s22, s23
    v_lshrrev_b32 v8, 2, v1
    v_add_u32 v8, s22, v8
    v_mul_u32_u24 v9, 1280, v8
    v_and_b32 v10, 3, v1
    v_lshlrev_b32 v10, 4, v10
    v_add_u32 v9, v9, v10
    v_mov_b32 v11, 0
    s_waitcnt lgkmcnt(0)
    s_add_u32 s60, s60, 0x9e3779b9
    buffer_load_dwordx4 v[32:35], v9, s[4:7], 0 offen offset:0
    buffer_load_dwordx4 v[72:75], v10, s[8:11], 0 offen offset:0
    buffer_load_dwordx4 v[36:39], v9, s[4:7], 0 offen offset:64
    buffer_load_dwordx4 v[76:79], v10, s[8:11], 0 offen offset:64
    buffer_load_dwordx4 v[40:43], v9, s[4:7], 0 offen offset:128
    buffer_load_dwordx4 v[80:83], v10, s[8:11], 0 offen offset:128
    buffer_load_dwordx4 v[44:47], v9, s[4:7], 0 offen offset:192
    buffer_load_dwordx4 v[84:87], v10, s[8:11], 0 offen offset:192
    buffer_load_dwordx4 v[48:51], v9, s[4:7], 0 offen offset:256
    buffer_load_dwordx4 v[88:91], v10, s[8:11], 0 offen offset:256
    buffer_load_dwordx4 v[52:55], v9, s[4:7], 0 offen offset:320
    buffer_load_dwordx4 v[92:95], v10, s[8:11], 0 offen offset:320
    buffer_load_dwordx4 v[56:59], v9, s[4:7], 0 offen offset:384
    buffer_load_dwordx4 v[96:99], v10, s[8:11], 0 offen offset:384
    buffer_load_dwordx4 v[60:63], v9, s[4:7], 0 offen offset:448
    buffer_load_dwordx4 v[100:103], v10, s[8:11], 0 offen offset:448
    buffer_load_dwordx4 v[64:67], v9, s[4:7], 0 offen offset:512
    buffer_load_dwordx4 v[104:107], v10, s[8:11], 0 offen offset:512
    buffer_load_dwordx4 v[68:71], v9, s[4:7], 0 offen offset:576
    buffer_load_dwordx4 v[108:111], v10, s[8:11], 0 offen offset:576
    s_waitcnt vmcnt(0)
    v_lshlrev_b32 v12, 16, v32
    v_lshlrev_b32 v13, 16, v72
    v_fmac_f32 v11, v12, v13
    v_and_b32 v12, 0xffff0000, v32
    v_and_b32 v13, 0xffff0000, v72
    v_fmac_f32 v11, v12, v13
    v_lshlrev_b32 v12, 16, v33
    v_lshlrev_b32 v13, 16, v73
    v_fmac_f32 v11, v12, v13
    v_and_b32 v12, 0xffff0000, v33
    v_and_b32 v13, 0xffff0000, v73
    v_fmac_f32 v11, v12, v13
    v_lshlrev_b32 v12, 16, v34
    v_lshlrev_b32 v13, 16, v74
    v_fmac_f32 v11, v12, v13
    v_and_b32 v12, 0xffff0000, v34
    v_and_b32 v13, 0xffff0000, v74
    v_fmac_f32 v11, v12, v13
    v_lshlrev_b32 v12, 16, v35
    v_lshlrev_b32 v13, 16, v75
    v_fmac_f32 v11, v12, v13
    v_and_b32 v12, 0xffff0000, v35
    v_and_b32 v13, 0xffff0000, v75
    v_fmac_f32 v11, v12, v13
    v_lshlrev_b32 v12, 16, v36
    v_lshlrev_b32 v13, 16, v76
    v_fmac_f32 v11, v12, v13
    v_and_b32 v12, 0xffff0000, v36
    v_and_b32 v13, 0xffff0000, v76
    v_fmac_f32 v11, v12, v13
    v_lshlrev_b32 v12, 16, v37
    v_lshlrev_b32 v13, 16, v77
    v_fmac_f32 v11, v12, v13
    v_and_b32 v12, 0xffff0000, v37
    v_and_b32 v13, 0xffff0000, v77
    v_fmac_f32 v11, v12, v13
    v_lshlrev_b32 v12, 16, v38
    v_lshlrev_b32 v13, 16, v78
    v_fmac_f32 v11, v12, v13
    v_and_b32 v12, 0xffff0000, v38
    v_and_b32 v13, 0xffff0000, v78
    v_fmac_f32 v11, v12, v13
    v_lshlrev_b32 v12, 16, v39
    v_lshlrev_b32 v13, 16, v79
    v_fmac_f32 v11, v12, v13
    v_and_b32 v12, 0xffff0000, v39
    v_and_b32 v13, 0xffff0000, v79
    v_fmac_f32 v11, v12, v13
    v_lshlrev_b32 v12, 16, v40
    v_lshlrev_b32 v13, 16, v80
    v_fmac_f32 v11, v12, v13
    v_and_b32 v12, 0xffff0000, v40
    v_and_b32 v13, 0xffff0000, v80
    v_fmac_f32 v11, v12, v13
    v_lshlrev_b32 v12, 16, v41
    v_lshlrev_b32 v13, 16, v81
    v_fmac_f32 v11, v12, v13
    v_and_b32 v12, 0xffff0000, v41
    v_and_b32 v13, 0xffff0000, v81
    v_fmac_f32 v11, v12, v13
    v_lshlrev_b32 v12, 16, v42
    v_lshlrev_b32 v13, 16, v82
    v_fmac_f32 v11, v12, v13
    v_and_b32 v12, 0xffff0000, v42
    v_and_b32 v13, 0xffff0000, v82
    v_fmac_f32 v11, v12, v13
    v_lshlrev_b32 v12, 16, v43
    v_lshlrev_b32 v13, 16, v83
    v_fmac_f32 v11, v12, v13
    v_and_b32 v12, 0xffff0000, v43
    v_and_b32 v13, 0xffff0000, v83
    v_fmac_f32 v11, v12, v13
    v_lshlrev_b32 v12, 16, v44
    v_lshlrev_b32 v13, 16, v84
    v_fmac_f32 v11, v12, v13
    v_and_b32 v12, 0xffff0000, v44
    v_and_b32 v13, 0xffff0000, v84
    v_fmac_f32 v11, v12, v13
    v_lshlrev_b32 v12, 16, v45
    v_lshlrev_b32 v13, 16, v85
    v_fmac_f32 v11, v12, v13
    v_and_b32 v12, 0xffff0000, v45
    v_and_b32 v13, 0xffff0000, v85
    v_fmac_f32 v11, v12, v13
    v_lshlrev_b32 v12, 16, v46
    v_lshlrev_b32 v13, 16, v86
    v_fmac_f32 v11, v12, v13
    v_and_b32 v12, 0xffff0000, v46
    v_and_b32 v13, 0xffff0000, v86
    v_fmac_f32 v11, v12, v13
    v_lshlrev_b32 v12, 16, v47
    v_lshlrev_b32 v13, 16, v87
    v_fmac_f32 v11, v12, v13
    v_and_b32 v12, 0xffff0000, v47
    v_and_b32 v13, 0xffff0000, v87
    v_fmac_f32 v11, v12, v13
    v_lshlrev_b32 v12, 16, v48
    v_lshlrev_b32 v13, 16, v88
    v_fmac_f32 v11, v12, v13
    v_and_b32 v12, 0xffff0000, v48
    v_and_b32 v13, 0xffff0000, v88
    v_fmac_f32 v11, v12, v13
    v_lshlrev_b32 v12, 16, v49
    v_lshlrev_b32 v13, 16, v89
    v_fmac_f32 v11, v12, v13
    v_and_b32 v12, 0xffff0000, v49
    v_and_b32 v13, 0xffff0000, v89
    v_fmac_f32 v11, v12, v13
    v_lshlrev_b32 v12, 16, v50
    v_lshlrev_b32 v13, 16, v90
    v_fmac_f32 v11, v12, v13
    v_and_b32 v12, 0xffff0000, v50
    v_and_b32 v13, 0xffff0000, v90
    v_fmac_f32 v11, v12, v13
    v_lshlrev_b32 v12, 16, v51
    v_lshlrev_b32 v13, 16, v91
    v_fmac_f32 v11, v12, v13
    v_and_b32 v12, 0xffff0000, v51
    v_and_b32 v13, 0xffff0000, v91
    v_fmac_f32 v11, v12, v13
    v_lshlrev_b32 v12, 16, v52
    v_lshlrev_b32 v13, 16, v92
    v_fmac_f32 v11, v12, v13
    v_and_b32 v12, 0xffff0000, v52
    v_and_b32 v13, 0xffff0000, v92
    v_fmac_f32 v11, v12, v13
    v_lshlrev_b32 v12, 16, v53
    v_lshlrev_b32 v13, 16, v93
    v_fmac_f32 v11, v12, v13
    v_and_b32 v12, 0xffff0000, v53
    v_and_b32 v13, 0xffff0000, v93
    v_fmac_f32 v11, v12, v13
    v_lshlrev_b32 v12, 16, v54
    v_lshlrev_b32 v13, 16, v94
    v_fmac_f32 v11, v12, v13
    v_and_b32 v12, 0xffff0000, v54
    v_and_b32 v13, 0xffff0000, v94
    v_fmac_f32 v11, v12, v13
    v_lshlrev_b32 v12, 16, v55
    v_lshlrev_b32 v13, 16, v95
    v_fmac_f32 v11, v12, v13
    v_and_b32 v12, 0xffff0000, v55
    v_and_b32 v13, 0xffff0000, v95
    v_fmac_f32 v11, v12, v13
    v_lshlrev_b32 v12, 16, v56
    v_lshlrev_b32 v13, 16, v96
    v_fmac_f32 v11, v12, v13
    v_and_b32 v12, 0xffff0000, v56
    v_and_b32 v13, 0xffff0000, v96
    v_fmac_f32 v11, v12, v13
    v_lshlrev_b32 v12, 16, v57
    v_lshlrev_b32 v13, 16, v97
    v_fmac_f32 v11, v12, v13
    v_and_b32 v12, 0xffff0000, v57
    v_and_b32 v13, 0xffff0000, v97
    v_fmac_f32 v11, v12, v13
    v_lshlrev_b32 v12, 16, v58
    v_lshlrev_b32 v13, 16, v98
    v_fmac_f32 v11, v12, v13
    v_and_b32 v12, 0xffff0000, v58
    v_and_b32 v13, 0xffff0000, v98
    v_fmac_f32 v11, v12, v13
    v_lshlrev_b32 v12, 16, v59
    v_lshlrev_b32 v13, 16, v99
    v_fmac_f32 v11, v12, v13
    v_and_b32 v12, 0xffff0000, v59
    v_and_b32 v13, 0xffff0000, v99
    v_fmac_f32 v11, v12, v13
    v_lshlrev_b32 v12, 16, v60
    v_lshlrev_b32 v13, 16, v100
    v_fmac_f32 v11, v12, v13
    v_and_b32 v12, 0xffff0000, v60
    v_and_b32 v13, 0xffff0000, v100
    v_fmac_f32 v11, v12, v13
    v_lshlrev_b32 v12, 16, v61
    v_lshlrev_b32 v13, 16, v101
    v_fmac_f32 v11, v12, v13
    v_and_b32 v12, 0xffff0000, v61
    v_and_b32 v13, 0xffff0000, v101
    v_fmac_f32 v11, v12, v13
    v_lshlrev_b32 v12, 16, v62
    v_lshlrev_b32 v13, 16, v102
    v_fmac_f32 v11, v12, v13
    v_and_b32 v12, 0xffff0000, v62
    v_and_b32 v13, 0xffff0000, v102
    v_fmac_f32 v11, v12, v13
    v_lshlrev_b32 v12, 16, v63
    v_lshlrev_b32 v13, 16, v103
    v_fmac_f32 v11, v12, v13
    v_and_b32 v12, 0xffff0000, v63
    v_and_b32 v13, 0xffff0000, v103
    v_fmac_f32 v11, v12, v13
    v_lshlrev_b32 v12, 16, v64
    v_lshlrev_b32 v13, 16, v104
    v_fmac_f32 v11, v12, v13
    v_and_b32 v12, 0xffff0000, v64
    v_and_b32 v13, 0xffff0000, v104
    v_fmac_f32 v11, v12, v13
    v_lshlrev_b32 v12, 16, v65
    v_lshlrev_b32 v13, 16, v105
    v_fmac_f32 v11, v12, v13
    v_and_b32 v12, 0xffff0000, v65
    v_and_b32 v13, 0xffff0000, v105
    v_fmac_f32 v11, v12, v13
    v_lshlrev_b32 v12, 16, v66
    v_lshlrev_b32 v13, 16, v106
    v_fmac_f32 v11, v12, v13
    v_and_b32 v12, 0xffff0000, v66
    v_and_b32 v13, 0xffff0000, v106
    v_fmac_f32 v11, v12, v13
    v_lshlrev_b32 v12, 16, v67
    v_lshlrev_b32 v13, 16, v107
    v_fmac_f32 v11, v12, v13
    v_and_b32 v12, 0xffff0000, v67
    v_and_b32 v13, 0xffff0000, v107
    v_fmac_f32 v11, v12, v13
    v_lshlrev_b32 v12, 16, v68
    v_lshlrev_b32 v13, 16, v108
    v_fmac_f32 v11, v12, v13
    v_and_b32 v12, 0xffff0000, v68
    v_and_b32 v13, 0xffff0000, v108
    v_fmac_f32 v11, v12, v13
    v_lshlrev_b32 v12, 16, v69
    v_lshlrev_b32 v13, 16, v109
    v_fmac_f32 v11, v12, v13
    v_and_b32 v12, 0xffff0000, v69
    v_and_b32 v13, 0xffff0000, v109
    v_fmac_f32 v11, v12, v13
    v_lshlrev_b32 v12, 16, v70
    v_lshlrev_b32 v13, 16, v110
    v_fmac_f32 v11, v12, v13
    v_and_b32 v12, 0xffff0000, v70
    v_and_b32 v13, 0xffff0000, v110
    v_fmac_f32 v11, v12, v13
    v_lshlrev_b32 v12, 16, v71
    v_lshlrev_b32 v13, 16, v111
    v_fmac_f32 v11, v12, v13
    v_and_b32 v12, 0xffff0000, v71
    v_and_b32 v13, 0xffff0000, v111
    v_fmac_f32 v11, v12, v13
    buffer_load_dwordx4 v[32:35], v9, s[4:7], 0 offen offset:640
    buffer_load_dwordx4 v[72:75], v10, s[8:11], 0 offen offset:640
    buffer_load_dwordx4 v[36:39], v9, s[4:7], 0 offen offset:704
    buffer_load_dwordx4 v[76:79], v10, s[8:11], 0 offen offset:704
    buffer_load_dwordx4 v[40:43], v9, s[4:7], 0 offen offset:768
    buffer_load_dwordx4 v[80:83], v10, s[8:11], 0 offen offset:768
    buffer_load_dwordx4 v[44:47], v9, s[4:7], 0 offen offset:832
    buffer_load_dwordx4 v[84:87], v10, s[8:11], 0 offen offset:832
    buffer_load_dwordx4 v[48:51], v9, s[4:7], 0 offen offset:896
    buffer_load_dwordx4 v[88:91], v10, s[8:11], 0 offen offset:896
    buffer_load_dwordx4 v[52:55], v9, s[4:7], 0 offen offset:960
    buffer_load_dwordx4 v[92:95], v10, s[8:11], 0 offen offset:960
    buffer_load_dwordx4 v[56:59], v9, s[4:7], 0 offen offset:1024
    buffer_load_dwordx4 v[96:99], v10, s[8:11], 0 offen offset:1024
    buffer_load_dwordx4 v[60:63], v9, s[4:7], 0 offen offset:1088
    buffer_load_dwordx4 v[100:103], v10, s[8:11], 0 offen offset:1088
    buffer_load_dwordx4 v[64:67], v9, s[4:7], 0 offen offset:1152
    buffer_load_dwordx4 v[104:107], v10, s[8:11], 0 offen offset:1152
    buffer_load_dwordx4 v[68:71], v9, s[4:7], 0 offen offset:1216
    buffer_load_dwordx4 v[108:111], v10, s[8:11], 0 offen offset:1216
    s_waitcnt vmcnt(0)
    v_lshlrev_b32 v12, 16, v32
    v_lshlrev_b32 v13, 16, v72
    v_fmac_f32 v11, v12, v13
    v_and_b32 v12, 0xffff0000, v32
    v_and_b32 v13, 0xffff0000, v72
    v_fmac_f32 v11, v12, v13
    v_lshlrev_b32 v12, 16, v33
    v_lshlrev_b32 v13, 16, v73
    v_fmac_f32 v11, v12, v13
    v_and_b32 v12, 0xffff0000, v33
    v_and_b32 v13, 0xffff0000, v73
    v_fmac_f32 v11, v12, v13
    v_lshlrev_b32 v12, 16, v34
    v_lshlrev_b32 v13, 16, v74
    v_fmac_f32 v11, v12, v13
    v_and_b32 v12, 0xffff0000, v34
    v_and_b32 v13, 0xffff0000, v74
    v_fmac_f32 v11, v12, v13
    v_lshlrev_b32 v12, 16, v35
    v_lshlrev_b32 v13, 16, v75
    v_fmac_f32 v11, v12, v13
    v_and_b32 v12, 0xffff0000, v35
    v_and_b32 v13, 0xffff0000, v75
    v_fmac_f32 v11, v12, v13
    v_lshlrev_b32 v12, 16, v36
    v_lshlrev_b32 v13, 16, v76
    v_fmac_f32 v11, v12, v13
    v_and_b32 v12, 0xffff0000, v36
    v_and_b32 v13, 0xffff0000, v76
    v_fmac_f32 v11, v12, v13
    v_lshlrev_b32 v12, 16, v37
    v_lshlrev_b32 v13, 16, v77
    v_fmac_f32 v11, v12, v13
    v_and_b32 v12, 0xffff0000, v37
    v_and_b32 v13, 0xffff0000, v77
    v_fmac_f32 v11, v12, v13
    v_lshlrev_b32 v12, 16, v38
    v_lshlrev_b32 v13, 16, v78
    v_fmac_f32 v11, v12, v13
    v_and_b32 v12, 0xffff0000, v38
    v_and_b32 v13, 0xffff0000, v78
    v_fmac_f32 v11, v12, v13
    v_lshlrev_b32 v12, 16, v39
    v_lshlrev_b32 v13, 16, v79
    v_fmac_f32 v11, v12, v13
    v_and_b32 v12, 0xffff0000, v39
    v_and_b32 v13, 0xffff0000, v79
    v_fmac_f32 v11, v12, v13
    v_lshlrev_b32 v12, 16, v40
    v_lshlrev_b32 v13, 16, v80
    v_fmac_f32 v11, v12, v13
    v_and_b32 v12, 0xffff0000, v40
    v_and_b32 v13, 0xffff0000, v80
    v_fmac_f32 v11, v12, v13
    v_lshlrev_b32 v12, 16, v41
    v_lshlrev_b32 v13, 16, v81
    v_fmac_f32 v11, v12, v13
    v_and_b32 v12, 0xffff0000, v41
    v_and_b32 v13, 0xffff0000, v81
    v_fmac_f32 v11, v12, v13
    v_lshlrev_b32 v12, 16, v42
    v_lshlrev_b32 v13, 16, v82
    v_fmac_f32 v11, v12, v13
    v_and_b32 v12, 0xffff0000, v42
    v_and_b32 v13, 0xffff0000, v82
    v_fmac_f32 v11, v12, v13
    v_lshlrev_b32 v12, 16, v43
    v_lshlrev_b32 v13, 16, v83
    v_fmac_f32 v11, v12, v13
    v_and_b32 v12, 0xffff0000, v43
    v_and_b32 v13, 0xffff0000, v83
    v_fmac_f32 v11, v12, v13
    v_lshlrev_b32 v12, 16, v44
    v_lshlrev_b32 v13, 16, v84
    v_fmac_f32 v11, v12, v13
    v_and_b32 v12, 0xffff0000, v44
    v_and_b32 v13, 0xffff0000, v84
    v_fmac_f32 v11, v12, v13
    v_lshlrev_b32 v12, 16, v45
    v_lshlrev_b32 v13, 16, v85
    v_fmac_f32 v11, v12, v13
    v_and_b32 v12, 0xffff0000, v45
    v_and_b32 v13, 0xffff0000, v85
    v_fmac_f32 v11, v12, v13
    v_lshlrev_b32 v12, 16, v46
    v_lshlrev_b32 v13, 16, v86
    v_fmac_f32 v11, v12, v13
    v_and_b32 v12, 0xffff0000, v46
    v_and_b32 v13, 0xffff0000, v86
    v_fmac_f32 v11, v12, v13
    v_lshlrev_b32 v12, 16, v47
    v_lshlrev_b32 v13, 16, v87
    v_fmac_f32 v11, v12, v13
    v_and_b32 v12, 0xffff0000, v47
    v_and_b32 v13, 0xffff0000, v87
    v_fmac_f32 v11, v12, v13
    v_lshlrev_b32 v12, 16, v48
    v_lshlrev_b32 v13, 16, v88
    v_fmac_f32 v11, v12, v13
    v_and_b32 v12, 0xffff0000, v48
    v_and_b32 v13, 0xffff0000, v88
    v_fmac_f32 v11, v12, v13
    v_lshlrev_b32 v12, 16, v49
    v_lshlrev_b32 v13, 16, v89
    v_fmac_f32 v11, v12, v13
    v_and_b32 v12, 0xffff0000, v49
    v_and_b32 v13, 0xffff0000, v89
    v_fmac_f32 v11, v12, v13
    v_lshlrev_b32 v12, 16, v50
    v_lshlrev_b32 v13, 16, v90
    v_fmac_f32 v11, v12, v13
    v_and_b32 v12, 0xffff0000, v50
    v_and_b32 v13, 0xffff0000, v90
    v_fmac_f32 v11, v12, v13
    v_lshlrev_b32 v12, 16, v51
    v_lshlrev_b32 v13, 16, v91
    v_fmac_f32 v11, v12, v13
    v_and_b32 v12, 0xffff0000, v51
    v_and_b32 v13, 0xffff0000, v91
    v_fmac_f32 v11, v12, v13
    v_lshlrev_b32 v12, 16, v52
    v_lshlrev_b32 v13, 16, v92
    v_fmac_f32 v11, v12, v13
    v_and_b32 v12, 0xffff0000, v52
    v_and_b32 v13, 0xffff0000, v92
    v_fmac_f32 v11, v12, v13
    v_lshlrev_b32 v12, 16, v53
    v_lshlrev_b32 v13, 16, v93
    v_fmac_f32 v11, v12, v13
    v_and_b32 v12, 0xffff0000, v53
    v_and_b32 v13, 0xffff0000, v93
    v_fmac_f32 v11, v12, v13
    v_lshlrev_b32 v12, 16, v54
    v_lshlrev_b32 v13, 16, v94
    v_fmac_f32 v11, v12, v13
    v_and_b32 v12, 0xffff0000, v54
    v_and_b32 v13, 0xffff0000, v94
    v_fmac_f32 v11, v12, v13
    v_lshlrev_b32 v12, 16, v55
    v_lshlrev_b32 v13, 16, v95
    v_fmac_f32 v11, v12, v13
    v_and_b32 v12, 0xffff0000, v55
    v_and_b32 v13, 0xffff0000, v95
    v_fmac_f32 v11, v12, v13
    v_lshlrev_b32 v12, 16, v56
    v_lshlrev_b32 v13, 16, v96
    v_fmac_f32 v11, v12, v13
    v_and_b32 v12, 0xffff0000, v56
    v_and_b32 v13, 0xffff0000, v96
    v_fmac_f32 v11, v12, v13
    v_lshlrev_b32 v12, 16, v57
    v_lshlrev_b32 v13, 16, v97
    v_fmac_f32 v11, v12, v13
    v_and_b32 v12, 0xffff0000, v57
    v_and_b32 v13, 0xffff0000, v97
    v_fmac_f32 v11, v12, v13
    v_lshlrev_b32 v12, 16, v58
    v_lshlrev_b32 v13, 16, v98
    v_fmac_f32 v11, v12, v13
    v_and_b32 v12, 0xffff0000, v58
    v_and_b32 v13, 0xffff0000, v98
    v_fmac_f32 v11, v12, v13
    v_lshlrev_b32 v12, 16, v59
    v_lshlrev_b32 v13, 16, v99
    v_fmac_f32 v11, v12, v13
    v_and_b32 v12, 0xffff0000, v59
    v_and_b32 v13, 0xffff0000, v99
    v_fmac_f32 v11, v12, v13
    v_lshlrev_b32 v12, 16, v60
    v_lshlrev_b32 v13, 16, v100
    v_fmac_f32 v11, v12, v13
    v_and_b32 v12, 0xffff0000, v60
    v_and_b32 v13, 0xffff0000, v100
    v_fmac_f32 v11, v12, v13
    v_lshlrev_b32 v12, 16, v61
    v_lshlrev_b32 v13, 16, v101
    v_fmac_f32 v11, v12, v13
    v_and_b32 v12, 0xffff0000, v61
    v_and_b32 v13, 0xffff0000, v101
    v_fmac_f32 v11, v12, v13
    v_lshlrev_b32 v12, 16, v62
    v_lshlrev_b32 v13, 16, v102
    v_fmac_f32 v11, v12, v13
    v_and_b32 v12, 0xffff0000, v62
    v_and_b32 v13, 0xffff0000, v102
    v_fmac_f32 v11, v12, v13
    v_lshlrev_b32 v12, 16, v63
    v_lshlrev_b32 v13, 16, v103
    v_fmac_f32 v11, v12, v13
    v_and_b32 v12, 0xffff0000, v63
    v_and_b32 v13, 0xffff0000, v103
    v_fmac_f32 v11, v12, v13
    v_lshlrev_b32 v12, 16, v64
    v_lshlrev_b32 v13, 16, v104
    v_fmac_f32 v11, v12, v13
    v_and_b32 v12, 0xffff0000, v64
    v_and_b32 v13, 0xffff0000, v104
    v_fmac_f32 v11, v12, v13
    v_lshlrev_b32 v12, 16, v65
    v_lshlrev_b32 v13, 16, v105
    v_fmac_f32 v11, v12, v13
    v_and_b32 v12, 0xffff0000, v65
    v_and_b32 v13, 0xffff0000, v105
    v_fmac_f32 v11, v12, v13
    v_lshlrev_b32 v12, 16, v66
    v_lshlrev_b32 v13, 16, v106
    v_fmac_f32 v11, v12, v13
    v_and_b32 v12, 0xffff0000, v66
    v_and_b32 v13, 0xffff0000, v106
    v_fmac_f32 v11, v12, v13
    v_lshlrev_b32 v12, 16, v67
    v_lshlrev_b32 v13, 16, v107
    v_fmac_f32 v11, v12, v13
    v_and_b32 v12, 0xffff0000, v67
    v_and_b32 v13, 0xffff0000, v107
    v_fmac_f32 v11, v12, v13
    v_lshlrev_b32 v12, 16, v68
    v_lshlrev_b32 v13, 16, v108
    v_fmac_f32 v11, v12, v13
    v_and_b32 v12, 0xffff0000, v68
    v_and_b32 v13, 0xffff0000, v108
    v_fmac_f32 v11, v12, v13
    v_lshlrev_b32 v12, 16, v69
    v_lshlrev_b32 v13, 16, v109
    v_fmac_f32 v11, v12, v13
    v_and_b32 v12, 0xffff0000, v69
    v_and_b32 v13, 0xffff0000, v109
    v_fmac_f32 v11, v12, v13
    v_lshlrev_b32 v12, 16, v70
    v_lshlrev_b32 v13, 16, v110
    v_fmac_f32 v11, v12, v13
    v_and_b32 v12, 0xffff0000, v70
    v_and_b32 v13, 0xffff0000, v110
    v_fmac_f32 v11, v12, v13
    v_lshlrev_b32 v12, 16, v71
    v_lshlrev_b32 v13, 16, v111
    v_fmac_f32 v11, v12, v13
    v_and_b32 v12, 0xffff0000, v71
    v_and_b32 v13, 0xffff0000, v111
    v_fmac_f32 v11, v12, v13
    s_nop 1
    v_add_f32_dpp v12, v11, v11 quad_perm:[1,0,3,2] row_mask:0xf bank_mask:0xf
    s_nop 1
    v_add_f32_dpp v11, v12, v12 quad_perm:[2,3,0,1] row_mask:0xf bank_mask:0xf
    v_mul_f32 v11, 3216550459, v11
    v_exp_f32 v11, v11
    s_nop 0
    v_add_f32 v11, 1.0, v11
    v_rcp_f32 v11, v11
    v_lshlrev_b32 v8, 2, v8
    v_and_b32 v10, 3, v1
    v_cmp_eq_u32 vcc, 0, v10
    s_nop 0
    s_and_saveexec_b64 s[32:33], vcc
    s_cbranch_execz q_gdone
    s_mov_b32 s22, 18874368
    buffer_store_dword v11, v8, s[12:15], s22 offen sc1
q_gdone:
    s_mov_b64 exec, -1
q_fin:
    s_waitcnt vmcnt(0)
    s_barrier
    s_cmp_eq_u32 s16, 0
    s_cbranch_scc0 q_sig
    s_mul_i32 s50, s18, 4352
    s_lshl_b32 s51, s17, 2
    s_add_u32 s50, s50, s51
    s_add_u32 s50, s50, 19922944
    v_mov_b32 v126, s60
    v_and_b32 v127, 63, v0
    v_mul_u32_u24 v127, 69888, v127
    s_mov_b64 exec, 255
    buffer_store_dword v126, v127, s[12:15], s50 offen sc1
    s_mov_b64 exec, -1
q_sig:
    v_lshrrev_b32 v112, 6, v0
    v_and_b32 v1, 63, v0
    v_readfirstlane_b32 s16, v112
    s_load_dwordx2 s[4:5], s[0:1], 80
    s_mov_b32 s6, 24117248
    s_mov_b32 s7, 0x20000
    s_waitcnt lgkmcnt(0)
    s_and_b32 s40, s2, 7
    s_lshr_b32 s41, s2, 3
    s_lshl_b32 s17, s40, 2
    s_and_b32 s42, s41, 3
    s_add_u32 s17, s17, s42
    s_lshr_b32 s18, s41, 2
    s_and_b32 s19, s16, 3
    s_lshr_b32 s20, s16, 2
    v_lshlrev_b32 v45, 4, v1
    s_lshl_b32 s40, s18, 3
    s_lshl_b32 s41, s19, 1
    s_add_u32 s40, s40, s41
    s_add_u32 s39, s40, s20
    s_and_b32 s41, s40, 3
    s_lshl_b32 s41, s41, 8
    s_lshr_b32 s40, s40, 2
    s_mul_i32 s40, s40, 5120
    s_add_u32 s40, s40, s41
    s_mul_i32 s41, s17, 81920
    s_add_u32 s40, s40, s41
    s_add_u32 s40, s40, 0
    v_and_b32 v112, 31, v1
    v_lshlrev_b32 v113, 3, v112
    v_lshlrev_b32 v114, 2, v112
    v_lshrrev_b32 v47, 5, v1
    v_lshlrev_b32 v47, 11, v47
    v_add_u32 v47, v47, v113
    s_mov_b32 s23, s40
    s_mul_i32 s40, s19, 3
    s_add_u32 s40, s40, 0
    s_min_u32 s40, s40, 10
    s_lshl_b32 s41, s40, 10
    s_mul_i32 s42, s20, 11264
    s_add_u32 s32, s41, s42
    s_mul_i32 s42, s17, 81920
    s_mul_i32 s43, s20, 40960
    s_add_u32 s42, s42, s43
    s_add_u32 s42, s42, s41
    s_add_u32 s24, s42, 2621440
    s_mul_i32 s42, s17, 98304
    s_mul_i32 s43, s20, 49152
    s_add_u32 s42, s42, s43
    s_add_u32 s42, s42, s41
    s_add_u32 s42, s42, 5237760
    s_mov_b32 s43, 6144
    s_cmp_lt_u32 s40, 5
    s_cselect_b32 s24, s24, s42
    s_cselect_b32 s28, 5120, s43
    s_mul_i32 s40, s19, 3
    s_add_u32 s40, s40, 1
    s_min_u32 s40, s40, 10
    s_lshl_b32 s41, s40, 10
    s_mul_i32 s42, s20, 11264
    s_add_u32 s33, s41, s42
    s_mul_i32 s42, s17, 81920
    s_mul_i32 s43, s20, 40960
    s_add_u32 s42, s42, s43
    s_add_u32 s42, s42, s41
    s_add_u32 s25, s42, 2621440
    s_mul_i32 s42, s17, 98304
    s_mul_i32 s43, s20, 49152
    s_add_u32 s42, s42, s43
    s_add_u32 s42, s42, s41
    s_add_u32 s42, s42, 5237760
    s_mov_b32 s43, 6144
    s_cmp_lt_u32 s40, 5
    s_cselect_b32 s25, s25, s42
    s_cselect_b32 s29, 5120, s43
    s_mul_i32 s40, s19, 3
    s_add_u32 s40, s40, 2
    s_min_u32 s40, s40, 10
    s_lshl_b32 s41, s40, 10
    s_mul_i32 s42, s20, 11264
    s_add_u32 s34, s41, s42
    s_mul_i32 s42, s17, 81920
    s_mul_i32 s43, s20, 40960
    s_add_u32 s42, s42, s43
    s_add_u32 s42, s42, s41
    s_add_u32 s26, s42, 2621440
    s_mul_i32 s42, s17, 98304
    s_mul_i32 s43, s20, 49152
    s_add_u32 s42, s42, s43
    s_add_u32 s42, s42, s41
    s_add_u32 s42, s42, 5237760
    s_mov_b32 s43, 6144
    s_cmp_lt_u32 s40, 5
    s_cselect_b32 s26, s26, s42
    s_cselect_b32 s30, 5120, s43
    s_mov_b32 s36, 0
    s_mul_i32 s40, s20, 11264
    v_add_u32 v2, s40, v47
    v_add_u32 v3, s40, v113
    v_add_u32 v3, 4096, v3
    v_and_b32 v115, 31, v1
    v_mov_b32 v116, 21
    v_cmp_lt_u32 vcc, 23, v115
    s_nop 1
    v_cndmask_b32 v116, v115, v116, vcc
    v_mov_b32 v117, 22
    v_cmp_lt_u32 vcc, 27, v115
    s_nop 1
    v_cndmask_b32 v116, v116, v117, vcc
    v_lshlrev_b32 v116, 4, v116
    v_lshrrev_b32 v117, 5, v1
    v_mul_u32_u24 v117, 384, v117
    v_add_u32 v118, v116, v117
    s_add_u32 s40, s40, 5120
    v_add_u32 v44, s40, v118
    v_mov_b32 v26, 0x3f803f80
    v_mov_b32 v27, 0
    v_cmp_gt_u32 s[44:45], 32, v1
    v_mov_b32 v80, 0
    v_mov_b32 v96, 0
    v_mov_b32 v81, 0
    v_mov_b32 v97, 0
    v_mov_b32 v82, 0
    v_mov_b32 v98, 0
    v_mov_b32 v83, 0
    v_mov_b32 v99, 0
    v_mov_b32 v84, 0
    v_mov_b32 v100, 0
    v_mov_b32 v85, 0
    v_mov_b32 v101, 0
    v_mov_b32 v86, 0
    v_mov_b32 v102, 0
    v_mov_b32 v87, 0
    v_mov_b32 v103, 0
    v_mov_b32 v88, 0
    v_mov_b32 v104, 0
    v_mov_b32 v89, 0
    v_mov_b32 v105, 0
    v_mov_b32 v90, 0
    v_mov_b32 v106, 0
    v_mov_b32 v91, 0
    v_mov_b32 v107, 0
    v_mov_b32 v92, 0
    v_mov_b32 v108, 0
    v_mov_b32 v93, 0
    v_mov_b32 v109, 0
    v_mov_b32 v94, 0
    v_mov_b32 v110, 0
    v_mov_b32 v95, 0
    v_mov_b32 v111, 0
    v_mov_b32 v40, 0
    v_mov_b32 v32, 0
    v_mov_b32 v41, 0
    v_mov_b32 v33, 0
    v_mov_b32 v42, 0
    v_mov_b32 v34, 0
    v_mov_b32 v43, 0
    v_mov_b32 v35, 0
    s_cmp_eq_u32 s16, 0
    s_cbranch_scc0 at_w_join
    s_mul_i32 s50, s17, 20
    v_lshrrev_b32 v124, 3, v1
    v_and_b32 v125, 1, v124
    v_mul_u32_u24 v125, 19, v125
    v_bfe_u32 v124, v1, 4, 1
    v_mul_u32_u24 v124, 640, v124
    v_add3_u32 v124, v124, v125, s50
    v_add_u32 v124, 640, v124
    v_lshrrev_b32 v124, 7, v124
    v_and_b32 v125, 7, v1
    v_lshlrev_b32 v125, 3, v125
    v_and_b32 v126, 1, v1
    v_mul_u32_u24 v126, 19, v126
    v_add_u32 v126, s50, v126
    v_lshrrev_b32 v126, 7, v126
    v_mov_b32 v127, 15
    v_cmp_lt_u32 vcc, 33, v1
    s_nop 1
    v_cndmask_b32 v126, v126, v127, vcc
    v_cmp_lt_u32 vcc, 31, v1
    s_nop 1
    v_cndmask_b32 v124, v124, v126, vcc
    s_lshl_b32 s52, s18, 3
    v_mov_b32 v126, s52
    v_cndmask_b32 v125, v125, v126, vcc
    v_mul_u32_u24 v124, 4352, v124
    s_and_b32 s52, s2, 7
    s_mul_i32 s52, s52, 69888
    s_add_u32 s52, s52, 19922944
    v_add3_u32 v127, v124, v125, s52
    s_mov_b32 s51, 100000
    s_sleep 56
at_w_poll:
    buffer_load_dwordx2 v[124:125], v127, s[4:7], 0 offen sc1
    s_waitcnt vmcnt(0)
    v_xor_b32 v124, s60, v124
    v_xor_b32 v125, s60, v125
    v_or_b32 v124, v124, v125
    v_cmp_ne_u32 vcc, 0, v124
    s_nop 1
    s_cmp_eq_u64 vcc, 0
    s_cbranch_scc1 at_w_ok
    s_sleep 56
    s_sub_u32 s51, s51, 1
    s_cmp_lg_u32 s51, 0
    s_cbranch_scc1 at_w_poll
at_w_ok:
at_w_join:
    s_barrier
    buffer_load_dwordx2 v[4:5], v47, s[4:7], s23 offen offset:0 sc1
    buffer_load_dwordx2 v[6:7], v47, s[4:7], s23 offen offset:1024 sc1
    buffer_load_dwordx2 v[12:13], v47, s[4:7], s23 offen offset:256 sc1
    buffer_load_dwordx2 v[14:15], v47, s[4:7], s23 offen offset:1280 sc1
    s_add_u32 s41, s23, 4096
    buffer_load_dwordx2 v[8:9], v113, s[4:7], s41 offen offset:0 sc1
    buffer_load_dwordx2 v[16:17], v113, s[4:7], s41 offen offset:256 sc1
    s_lshl_b32 s41, s39, 7
    s_add_u32 s41, s41, 18874368
    buffer_load_dword v46, v114, s[4:7], s41 offen sc1
    s_add_u32 m0, s36, s32
    s_nop 0
    buffer_load_dwordx4 v45, s[4:7], s24 offen sc1 lds
    s_add_u32 s24, s24, s28
    s_add_u32 m0, s36, s33
    s_nop 0
    buffer_load_dwordx4 v45, s[4:7], s25 offen sc1 lds
    s_add_u32 s25, s25, s29
    s_add_u32 m0, s36, s34
    s_nop 0
    buffer_load_dwordx4 v45, s[4:7], s26 offen sc1 lds
    s_add_u32 s26, s26, s30
    s_add_u32 s36, s36, 22528
    s_cmp_eq_u32 s36, 67584
    s_cselect_b32 s36, 0, s36
    s_add_u32 m0, s36, s32
    s_nop 0
    buffer_load_dwordx4 v45, s[4:7], s24 offen sc1 lds
    s_add_u32 s24, s24, s28
    s_add_u32 m0, s36, s33
    s_nop 0
    buffer_load_dwordx4 v45, s[4:7], s25 offen sc1 lds
    s_add_u32 s25, s25, s29
    s_add_u32 m0, s36, s34
    s_nop 0
    buffer_load_dwordx4 v45, s[4:7], s26 offen sc1 lds
    s_add_u32 s26, s26, s30
    s_add_u32 s36, s36, 22528
    s_cmp_eq_u32 s36, 67584
    s_cselect_b32 s36, 0, s36
    s_waitcnt vmcnt(3)
    v_cndmask_b32 v8, 0, v8, s[44:45]
    v_cndmask_b32 v9, 0, v9, s[44:45]
    v_mov_b32 v10, 0
    v_mov_b32 v11, 0
    v_cndmask_b32 v16, 0, v16, s[44:45]
    v_cndmask_b32 v17, 0, v17, s[44:45]
    v_mov_b32 v18, 0
    v_mov_b32 v19, 0
    s_barrier
    v_add_u32 v119, 4096, v113
    ds_read2_b64 v[20:23], v47 offset0:0 offset1:128
    ds_read_b64 v[24:25], v119
    s_waitcnt lgkmcnt(0)
    v_mfma_f32_32x32x16_bf16 v[48:63], v[20:23], v[4:7], 0
    v_mfma_f32_32x32x16_bf16 v[48:63], v[24:27], v[8:11], v[48:63]
    v_mfma_f32_32x32x16_bf16 v[64:79], v[20:23], v[12:15], 0
    v_mfma_f32_32x32x16_bf16 v[64:79], v[24:27], v[16:19], v[64:79]
    s_nop 9
    v_max3_f32 v120, v48, v49, v50
    v_max3_f32 v120, v120, v51, v52
    v_max3_f32 v120, v120, v53, v54
    v_max3_f32 v120, v120, v55, v56
    v_max3_f32 v120, v120, v57, v58
    v_max3_f32 v120, v120, v59, v60
    v_max3_f32 v120, v120, v61, v62
    v_max_f32 v120, v120, v63
    v_mov_b32 v121, v120
    s_nop 1
    v_permlane32_swap_b32 v120, v121
    v_max_f32 v121, v120, v121
    v_xor_b32 v121, 0x80000000, v121
    v_and_b32 v122, 0xffff0000, v121
    v_sub_f32 v121, v121, v122
    v_and_b32 v123, 0xffff0000, v121
    v_sub_f32 v121, v121, v123
    v_lshrrev_b32 v122, 16, v122
    v_or_b32 v122, v122, v123
    v_lshrrev_b32 v121, 16, v121
    v_cndmask_b32 v10, v121, v122, s[44:45]
    v_max3_f32 v120, v64, v65, v66
    v_max3_f32 v120, v120, v67, v68
    v_max3_f32 v120, v120, v69, v70
    v_max3_f32 v120, v120, v71, v72
    v_max3_f32 v120, v120, v73, v74
    v_max3_f32 v120, v120, v75, v76
    v_max3_f32 v120, v120, v77, v78
    v_max_f32 v120, v120, v79
    v_mov_b32 v121, v120
    s_nop 1
    v_permlane32_swap_b32 v120, v121
    v_max_f32 v121, v120, v121
    v_xor_b32 v121, 0x80000000, v121
    v_and_b32 v122, 0xffff0000, v121
    v_sub_f32 v121, v121, v122
    v_and_b32 v123, 0xffff0000, v121
    v_sub_f32 v121, v121, v123
    v_lshrrev_b32 v122, 16, v122
    v_or_b32 v122, v122, v123
    v_lshrrev_b32 v121, 16, v121
    v_cndmask_b32 v18, v121, v122, s[44:45]
    ds_read2_b64 v[20:23], v2 offset0:0 offset1:128
    ds_read_b64 v[24:25], v3
    ds_read_b128 v[28:31], v44
    s_waitcnt lgkmcnt(1)
    v_mfma_f32_32x32x16_bf16 v[48:63], v[20:23], v[4:7], 0
    v_mfma_f32_32x32x16_bf16 v[48:63], v[24:27], v[8:11], v[48:63]
    s_mov_b32 s38, 0
    s_mov_b32 s37, 0
    s_mov_b32 s46, 22528
    s_nop 7
    s_nop 3
    s_setprio 0
.p2align 6
at_loop:
    v_exp_f32 v48, v48
    v_exp_f32 v49, v49
    v_mfma_f32_32x32x16_bf16 v[96:111], v[32:35], v[40:43], v[96:111]
    ds_read_b128 v[32:35], v44 offset:768
    v_exp_f32 v50, v50
    v_exp_f32 v51, v51
    v_cvt_pk_bf16_f32 v36, v48, v49
    v_exp_f32 v52, v52
    v_mfma_f32_32x32x16_bf16 v[64:79], v[20:23], v[12:15], 0
    v_exp_f32 v53, v53
    v_cvt_pk_bf16_f32 v37, v50, v51
    v_exp_f32 v54, v54
    v_exp_f32 v55, v55
    v_cvt_pk_bf16_f32 v38, v52, v53
    v_cvt_pk_bf16_f32 v39, v54, v55
    v_mfma_f32_32x32x16_bf16 v[64:79], v[24:27], v[16:19], v[64:79]
    ds_read2_b64 v[20:23], v2 offset0:32 offset1:160
    ds_read_b64 v[24:25], v3 offset:256
    v_exp_f32 v56, v56
    v_exp_f32 v57, v57
    v_exp_f32 v58, v58
    v_exp_f32 v59, v59
    v_cvt_pk_bf16_f32 v40, v56, v57
    s_waitcnt lgkmcnt(3)
    v_mfma_f32_32x32x16_bf16 v[80:95], v[28:31], v[36:39], v[80:95]
    v_exp_f32 v60, v60
    v_exp_f32 v61, v61
    v_cvt_pk_bf16_f32 v41, v58, v59
    v_exp_f32 v62, v62
    v_exp_f32 v63, v63
    v_cvt_pk_bf16_f32 v42, v60, v61
    v_cvt_pk_bf16_f32 v43, v62, v63
    v_exp_f32 v64, v64
    v_exp_f32 v65, v65
    s_waitcnt lgkmcnt(2)
    v_mfma_f32_32x32x16_bf16 v[80:95], v[32:35], v[40:43], v[80:95]
    v_exp_f32 v66, v66
    v_exp_f32 v67, v67
    v_cvt_pk_bf16_f32 v36, v64, v65
    v_exp_f32 v68, v68
    s_waitcnt lgkmcnt(1)
    v_mfma_f32_32x32x16_bf16 v[48:63], v[20:23], v[4:7], 0
    v_exp_f32 v69, v69
    v_cvt_pk_bf16_f32 v37, v66, v67
    v_exp_f32 v70, v70
    v_exp_f32 v71, v71
    v_cvt_pk_bf16_f32 v38, v68, v69
    v_cvt_pk_bf16_f32 v39, v70, v71
    s_waitcnt lgkmcnt(0)
    v_mfma_f32_32x32x16_bf16 v[48:63], v[24:27], v[8:11], v[48:63]
    v_exp_f32 v72, v72
    v_exp_f32 v73, v73
    v_exp_f32 v74, v74
    v_exp_f32 v75, v75
    v_cvt_pk_bf16_f32 v40, v72, v73
    v_mfma_f32_32x32x16_bf16 v[96:111], v[28:31], v[36:39], v[96:111]
    ds_read_b128 v[28:31], v44 offset:1536
    v_exp_f32 v76, v76
    v_exp_f32 v77, v77
    v_cvt_pk_bf16_f32 v41, v74, v75
    v_exp_f32 v78, v78
    v_exp_f32 v79, v79
    v_cvt_pk_bf16_f32 v42, v76, v77
    v_cvt_pk_bf16_f32 v43, v78, v79
    v_exp_f32 v48, v48
    v_exp_f32 v49, v49
    v_mfma_f32_32x32x16_bf16 v[96:111], v[32:35], v[40:43], v[96:111]
    ds_read_b128 v[32:35], v44 offset:2304
    v_exp_f32 v50, v50
    v_exp_f32 v51, v51
    v_cvt_pk_bf16_f32 v36, v48, v49
    v_exp_f32 v52, v52
    v_mfma_f32_32x32x16_bf16 v[64:79], v[20:23], v[12:15], 0
    v_exp_f32 v53, v53
    v_cvt_pk_bf16_f32 v37, v50, v51
    v_exp_f32 v54, v54
    v_exp_f32 v55, v55
    v_cvt_pk_bf16_f32 v38, v52, v53
    v_cvt_pk_bf16_f32 v39, v54, v55
    v_mfma_f32_32x32x16_bf16 v[64:79], v[24:27], v[16:19], v[64:79]
    ds_read2_b64 v[20:23], v2 offset0:64 offset1:192
    ds_read_b64 v[24:25], v3 offset:512
    v_exp_f32 v56, v56
    v_exp_f32 v57, v57
    v_exp_f32 v58, v58
    v_exp_f32 v59, v59
    v_cvt_pk_bf16_f32 v40, v56, v57
    s_waitcnt lgkmcnt(3)
    v_mfma_f32_32x32x16_bf16 v[80:95], v[28:31], v[36:39], v[80:95]
    v_exp_f32 v60, v60
    v_exp_f32 v61, v61
    v_cvt_pk_bf16_f32 v41, v58, v59
    v_exp_f32 v62, v62
    v_exp_f32 v63, v63
    v_cvt_pk_bf16_f32 v42, v60, v61
    v_cvt_pk_bf16_f32 v43, v62, v63
    v_exp_f32 v64, v64
    v_exp_f32 v65, v65
    s_waitcnt lgkmcnt(2)
    v_mfma_f32_32x32x16_bf16 v[80:95], v[32:35], v[40:43], v[80:95]
    v_exp_f32 v66, v66
    v_exp_f32 v67, v67
    v_cvt_pk_bf16_f32 v36, v64, v65
    v_exp_f32 v68, v68
    s_waitcnt lgkmcnt(1)
    v_mfma_f32_32x32x16_bf16 v[48:63], v[20:23], v[4:7], 0
    v_exp_f32 v69, v69
    v_cvt_pk_bf16_f32 v37, v66, v67
    v_exp_f32 v70, v70
    v_exp_f32 v71, v71
    v_cvt_pk_bf16_f32 v38, v68, v69
    v_cvt_pk_bf16_f32 v39, v70, v71
    s_waitcnt lgkmcnt(0)
    v_mfma_f32_32x32x16_bf16 v[48:63], v[24:27], v[8:11], v[48:63]
    v_exp_f32 v72, v72
    v_exp_f32 v73, v73
    v_exp_f32 v74, v74
    v_exp_f32 v75, v75
    v_cvt_pk_bf16_f32 v40, v72, v73
    v_mfma_f32_32x32x16_bf16 v[96:111], v[28:31], v[36:39], v[96:111]
    ds_read_b128 v[28:31], v44 offset:3072
    v_exp_f32 v76, v76
    v_exp_f32 v77, v77
    v_cvt_pk_bf16_f32 v41, v74, v75
    v_exp_f32 v78, v78
    v_exp_f32 v79, v79
    v_cvt_pk_bf16_f32 v42, v76, v77
    v_cvt_pk_bf16_f32 v43, v78, v79
    s_waitcnt vmcnt(0)
    s_barrier
    s_cmp_ge_u32 s38, 6
    s_cbranch_scc1 at_nodma
    s_add_u32 m0, s36, s32
    s_nop 0
    buffer_load_dwordx4 v45, s[4:7], s24 offen sc1 lds
    s_add_u32 s24, s24, s28
    s_add_u32 m0, s36, s33
    s_nop 0
    buffer_load_dwordx4 v45, s[4:7], s25 offen sc1 lds
    s_add_u32 s25, s25, s29
    s_add_u32 m0, s36, s34
    s_nop 0
    buffer_load_dwordx4 v45, s[4:7], s26 offen sc1 lds
    s_add_u32 s26, s26, s30
    s_add_u32 s36, s36, 22528
    s_cmp_eq_u32 s36, 67584
    s_cselect_b32 s36, 0, s36
at_nodma:
    v_exp_f32 v48, v48
    v_exp_f32 v49, v49
    v_mfma_f32_32x32x16_bf16 v[96:111], v[32:35], v[40:43], v[96:111]
    ds_read_b128 v[32:35], v44 offset:3840
    v_exp_f32 v50, v50
    v_exp_f32 v51, v51
    v_cvt_pk_bf16_f32 v36, v48, v49
    v_exp_f32 v52, v52
    v_mfma_f32_32x32x16_bf16 v[64:79], v[20:23], v[12:15], 0
    v_exp_f32 v53, v53
    v_cvt_pk_bf16_f32 v37, v50, v51
    v_exp_f32 v54, v54
    v_exp_f32 v55, v55
    v_cvt_pk_bf16_f32 v38, v52, v53
    v_cvt_pk_bf16_f32 v39, v54, v55
    v_mfma_f32_32x32x16_bf16 v[64:79], v[24:27], v[16:19], v[64:79]
    ds_read2_b64 v[20:23], v2 offset0:96 offset1:224
    ds_read_b64 v[24:25], v3 offset:768
    v_exp_f32 v56, v56
    v_exp_f32 v57, v57
    v_exp_f32 v58, v58
    v_exp_f32 v59, v59
    v_cvt_pk_bf16_f32 v40, v56, v57
    s_waitcnt lgkmcnt(3)
    v_mfma_f32_32x32x16_bf16 v[80:95], v[28:31], v[36:39], v[80:95]
    v_exp_f32 v60, v60
    v_exp_f32 v61, v61
    v_cvt_pk_bf16_f32 v41, v58, v59
    v_exp_f32 v62, v62
    v_exp_f32 v63, v63
    v_cvt_pk_bf16_f32 v42, v60, v61
    v_cvt_pk_bf16_f32 v43, v62, v63
    v_exp_f32 v64, v64
    v_exp_f32 v65, v65
    s_waitcnt lgkmcnt(2)
    v_mfma_f32_32x32x16_bf16 v[80:95], v[32:35], v[40:43], v[80:95]
    v_exp_f32 v66, v66
    v_exp_f32 v67, v67
    v_cvt_pk_bf16_f32 v36, v64, v65
    v_exp_f32 v68, v68
    s_waitcnt lgkmcnt(1)
    v_mfma_f32_32x32x16_bf16 v[48:63], v[20:23], v[4:7], 0
    v_exp_f32 v69, v69
    v_cvt_pk_bf16_f32 v37, v66, v67
    v_exp_f32 v70, v70
    v_exp_f32 v71, v71
    v_cvt_pk_bf16_f32 v38, v68, v69
    v_cvt_pk_bf16_f32 v39, v70, v71
    s_waitcnt lgkmcnt(0)
    v_mfma_f32_32x32x16_bf16 v[48:63], v[24:27], v[8:11], v[48:63]
    v_exp_f32 v72, v72
    v_exp_f32 v73, v73
    v_exp_f32 v74, v74
    v_exp_f32 v75, v75
    v_cvt_pk_bf16_f32 v40, v72, v73
    v_mfma_f32_32x32x16_bf16 v[96:111], v[28:31], v[36:39], v[96:111]
    ds_read_b128 v[28:31], v44 offset:4608
    v_exp_f32 v76, v76
    v_exp_f32 v77, v77
    v_cvt_pk_bf16_f32 v41, v74, v75
    v_exp_f32 v78, v78
    v_exp_f32 v79, v79
    v_cvt_pk_bf16_f32 v42, v76, v77
    v_cvt_pk_bf16_f32 v43, v78, v79
    v_exp_f32 v48, v48
    v_exp_f32 v49, v49
    v_mfma_f32_32x32x16_bf16 v[96:111], v[32:35], v[40:43], v[96:111]
    ds_read_b128 v[32:35], v44 offset:5376
    v_exp_f32 v50, v50
    v_exp_f32 v51, v51
    v_cvt_pk_bf16_f32 v36, v48, v49
    v_exp_f32 v52, v52
    v_mfma_f32_32x32x16_bf16 v[64:79], v[20:23], v[12:15], 0
    v_exp_f32 v53, v53
    v_cvt_pk_bf16_f32 v37, v50, v51
    v_exp_f32 v54, v54
    v_exp_f32 v55, v55
    v_cvt_pk_bf16_f32 v38, v52, v53
    v_cvt_pk_bf16_f32 v39, v54, v55
    v_mfma_f32_32x32x16_bf16 v[64:79], v[24:27], v[16:19], v[64:79]
    s_add_u32 s37, s37, 1
    s_cmp_eq_u32 s37, 3
    s_cselect_b32 s40, 4294922240, s46
    s_cselect_b32 s37, 0, s37
    v_add_u32 v2, s40, v2
    v_add_u32 v3, s40, v3
    ds_read2_b64 v[20:23], v2 offset0:0 offset1:128
    ds_read_b64 v[24:25], v3 offset:0
    v_exp_f32 v56, v56
    v_exp_f32 v57, v57
    v_exp_f32 v58, v58
    v_exp_f32 v59, v59
    v_cvt_pk_bf16_f32 v40, v56, v57
    s_waitcnt lgkmcnt(3)
    v_mfma_f32_32x32x16_bf16 v[80:95], v[28:31], v[36:39], v[80:95]
    v_exp_f32 v60, v60
    v_exp_f32 v61, v61
    v_cvt_pk_bf16_f32 v41, v58, v59
    v_exp_f32 v62, v62
    v_exp_f32 v63, v63
    v_cvt_pk_bf16_f32 v42, v60, v61
    v_cvt_pk_bf16_f32 v43, v62, v63
    v_exp_f32 v64, v64
    v_exp_f32 v65, v65
    s_waitcnt lgkmcnt(2)
    v_mfma_f32_32x32x16_bf16 v[80:95], v[32:35], v[40:43], v[80:95]
    v_exp_f32 v66, v66
    v_exp_f32 v67, v67
    v_cvt_pk_bf16_f32 v36, v64, v65
    v_exp_f32 v68, v68
    s_waitcnt lgkmcnt(1)
    v_mfma_f32_32x32x16_bf16 v[48:63], v[20:23], v[4:7], 0
    v_exp_f32 v69, v69
    v_cvt_pk_bf16_f32 v37, v66, v67
    v_exp_f32 v70, v70
    v_exp_f32 v71, v71
    v_cvt_pk_bf16_f32 v38, v68, v69
    v_cvt_pk_bf16_f32 v39, v70, v71
    s_waitcnt lgkmcnt(0)
    v_mfma_f32_32x32x16_bf16 v[48:63], v[24:27], v[8:11], v[48:63]
    v_exp_f32 v72, v72
    v_exp_f32 v73, v73
    v_exp_f32 v74, v74
    v_exp_f32 v75, v75
    v_cvt_pk_bf16_f32 v40, v72, v73
    v_mfma_f32_32x32x16_bf16 v[96:111], v[28:31], v[36:39], v[96:111]
    v_add_u32 v44, s40, v44
    ds_read_b128 v[28:31], v44 offset:0
    v_exp_f32 v76, v76
    v_exp_f32 v77, v77
    v_cvt_pk_bf16_f32 v41, v74, v75
    v_exp_f32 v78, v78
    v_exp_f32 v79, v79
    v_cvt_pk_bf16_f32 v42, v76, v77
    v_cvt_pk_bf16_f32 v43, v78, v79
    s_add_u32 s38, s38, 1
    s_cmp_lt_u32 s38, 8
    s_cbranch_scc1 at_loop
    v_mfma_f32_32x32x16_bf16 v[96:111], v[32:35], v[40:43], v[96:111]
    s_mul_i32 s40, s16, 3072
    s_add_u32 s40, s40, 45056
    v_add_u32 v120, s40, v45
    s_xor_b32 s41, s16, 4
    s_mul_i32 s41, s41, 3072
    s_add_u32 s41, s41, 45056
    v_add_u32 v121, s41, v45
    s_cmp_eq_u32 s20, 0
    s_cbranch_scc0 at_m1
    s_nop 2
    ds_write_b128 v120, v[96:99] offset:0
    ds_write_b128 v120, v[100:103] offset:1024
    ds_write_b128 v120, v[104:107] offset:2048
    s_waitcnt lgkmcnt(0)
    s_barrier
    ds_read_b128 v[60:63], v121 offset:0
    ds_read_b128 v[64:67], v121 offset:1024
    ds_read_b128 v[68:71], v121 offset:2048
    v_mov_b32 v72, v4
    v_mov_b32 v76, v8
    v_mov_b32 v73, v5
    v_mov_b32 v77, v9
    v_mov_b32 v74, v6
    v_mov_b32 v78, v10
    v_mov_b32 v75, v7
    v_mov_b32 v79, v11
    s_waitcnt lgkmcnt(0)
    v_add_f32 v48, v80, v60
    v_add_f32 v49, v81, v61
    v_add_f32 v50, v82, v62
    v_add_f32 v51, v83, v63
    v_add_f32 v52, v84, v64
    v_add_f32 v53, v85, v65
    v_add_f32 v54, v86, v66
    v_add_f32 v55, v87, v67
    v_add_f32 v56, v88, v68
    v_add_f32 v57, v89, v69
    v_add_f32 v58, v90, v70
    v_add_f32 v59, v91, v71
    s_branch at_merged
at_m1:
    ds_write_b128 v120, v[80:83] offset:0
    ds_write_b128 v120, v[84:87] offset:1024
    ds_write_b128 v120, v[88:91] offset:2048
    s_waitcnt lgkmcnt(0)
    s_barrier
    ds_read_b128 v[60:63], v121 offset:0
    ds_read_b128 v[64:67], v121 offset:1024
    ds_read_b128 v[68:71], v121 offset:2048
    v_mov_b32 v72, v12
    v_mov_b32 v76, v16
    v_mov_b32 v73, v13
    v_mov_b32 v77, v17
    v_mov_b32 v74, v14
    v_mov_b32 v78, v18
    v_mov_b32 v75, v15
    v_mov_b32 v79, v19
    s_waitcnt lgkmcnt(0)
    v_add_f32 v48, v96, v60
    v_add_f32 v49, v97, v61
    v_add_f32 v50, v98, v62
    v_add_f32 v51, v99, v63
    v_add_f32 v52, v100, v64
    v_add_f32 v53, v101, v65
    v_add_f32 v54, v102, v66
    v_add_f32 v55, v103, v67
    v_add_f32 v56, v104, v68
    v_add_f32 v57, v105, v69
    v_add_f32 v58, v106, v70
    v_add_f32 v59, v107, v71
at_merged:
    v_mov_b32 v122, v56
    v_mov_b32 v123, v56
    s_nop 1
    v_permlane32_swap_b32 v122, v123
    s_mov_b32 s40, 1400897536
    v_cmp_nle_f32 vcc, v123, s40
    s_nop 1
    s_cbranch_vccnz at_slow
at_fin:
    v_rcp_f32 v123, v123
    s_nop 0
    v_mul_f32 v123, v46, v123
    v_mul_f32 v48, v48, v123
    v_mul_f32 v49, v49, v123
    v_mul_f32 v50, v50, v123
    v_mul_f32 v51, v51, v123
    v_mul_f32 v52, v52, v123
    v_mul_f32 v53, v53, v123
    v_mul_f32 v54, v54, v123
    v_mul_f32 v55, v55, v123
    v_mul_f32 v56, v56, v123
    v_mul_f32 v57, v57, v123
    v_mul_f32 v58, v58, v123
    v_mul_f32 v59, v59, v123
    v_cvt_pk_bf16_f32 v36, v48, v49
    v_cvt_pk_bf16_f32 v37, v50, v51
    v_cvt_pk_bf16_f32 v38, v52, v53
    v_cvt_pk_bf16_f32 v39, v54, v55
    v_cvt_pk_bf16_f32 v40, v56, v57
    v_cvt_pk_bf16_f32 v41, v58, v59
    s_mul_i32 s40, s39, 40960
    s_add_u32 s40, s40, 15728640
    s_lshl_b32 s41, s17, 10
    s_add_u32 s41, s41, s40
    buffer_store_dwordx4 v[36:39], v45, s[4:7], s41 offen sc1
    s_lshr_b32 s41, s17, 2
    s_add_u32 s41, s41, 32
    s_lshl_b32 s41, s41, 10
    s_add_u32 s41, s41, s40
    s_lshl_b32 s42, s17, 8
    s_and_b32 s42, s42, 512
    s_add_u32 s41, s41, s42
    s_lshl_b32 s42, s17, 3
    s_and_b32 s42, s42, 8
    s_add_u32 s41, s41, s42
    s_mov_b64 exec, s[44:45]
    buffer_store_dwordx2 v[40:41], v45, s[4:7], s41 offen sc1
    s_mov_b64 exec, -1
    s_waitcnt vmcnt(0)
    s_mul_i32 s50, s39, 4352
    s_lshl_b32 s51, s17, 2
    s_add_u32 s50, s50, s51
    s_add_u32 s50, s50, 20551680
    v_mov_b32 v126, s60
    v_mov_b32 v127, 0
    s_mov_b64 exec, 1
    buffer_store_dword v126, v127, s[4:7], s50 offen sc1
    s_mov_b64 exec, -1
    s_endpgm
at_slow:
    s_mul_i32 s40, s17, 81920
    s_add_u32 s40, s40, 2621440
    v_and_b32 v113, 31, v1
    v_lshlrev_b32 v113, 3, v113
    v_add_u32 v113, 4096, v113
    v_mov_b32 v78, 0
    v_mov_b32 v120, 0xff800000
    s_mov_b32 s38, 0
at_s1:
    buffer_load_dwordx2 v[20:21], v47, s[4:7], s40 offen sc1
    buffer_load_dwordx2 v[22:23], v47, s[4:7], s40 offen offset:1024 sc1
    buffer_load_dwordx2 v[24:25], v113, s[4:7], s40 offen sc1
    s_waitcnt vmcnt(0)
    v_mfma_f32_32x32x16_bf16 v[80:95], v[20:23], v[72:75], 0
    v_mfma_f32_32x32x16_bf16 v[80:95], v[24:27], v[76:79], v[80:95]
    s_nop 11
    v_max3_f32 v120, v120, v80, v81
    v_max3_f32 v120, v120, v82, v83
    v_max3_f32 v120, v120, v84, v85
    v_max3_f32 v120, v120, v86, v87
    v_max3_f32 v120, v120, v88, v89
    v_max3_f32 v120, v120, v90, v91
    v_max3_f32 v120, v120, v92, v93
    v_max3_f32 v120, v120, v94, v95
    s_add_u32 s38, s38, 1
    s_and_b32 s42, s38, 3
    s_cmp_eq_u32 s42, 0
    s_cselect_b32 s42, 4096, 0
    s_add_u32 s42, s42, 256
    s_sub_u32 s38, s38, 1
    s_add_u32 s40, s40, s42
    s_add_u32 s38, s38, 1
    s_cmp_lt_u32 s38, 64
    s_cbranch_scc1 at_s1
    v_mov_b32 v121, v120
    s_nop 1
    v_permlane32_swap_b32 v120, v121
    v_max_f32 v121, v120, v121
    v_xor_b32 v121, 0x80000000, v121
    v_and_b32 v122, 0xffff0000, v121
    v_sub_f32 v121, v121, v122
    v_and_b32 v123, 0xffff0000, v121
    v_sub_f32 v121, v121, v123
    v_lshrrev_b32 v122, 16, v122
    v_or_b32 v122, v122, v123
    v_lshrrev_b32 v121, 16, v121
    v_cndmask_b32 v78, v121, v122, s[44:45]
    s_mul_i32 s40, s17, 81920
    s_add_u32 s40, s40, 2621440
    s_mul_i32 s41, s17, 98304
    s_add_u32 s41, s41, 5242880
    s_mov_b32 s38, 0
    v_mov_b32 v96, 0
    v_mov_b32 v97, 0
    v_mov_b32 v98, 0
    v_mov_b32 v99, 0
    v_mov_b32 v100, 0
    v_mov_b32 v101, 0
    v_mov_b32 v102, 0
    v_mov_b32 v103, 0
    v_mov_b32 v104, 0
    v_mov_b32 v105, 0
    v_mov_b32 v106, 0
    v_mov_b32 v107, 0
    v_mov_b32 v108, 0
    v_mov_b32 v109, 0
    v_mov_b32 v110, 0
    v_mov_b32 v111, 0
at_s2:
    buffer_load_dwordx2 v[20:21], v47, s[4:7], s40 offen sc1
    buffer_load_dwordx2 v[22:23], v47, s[4:7], s40 offen offset:1024 sc1
    buffer_load_dwordx2 v[24:25], v113, s[4:7], s40 offen sc1
    buffer_load_dwordx4 v[28:31], v118, s[4:7], s41 offen sc1
    buffer_load_dwordx4 v[32:35], v118, s[4:7], s41 offen offset:768 sc1
    s_waitcnt vmcnt(0)
    v_mfma_f32_32x32x16_bf16 v[80:95], v[20:23], v[72:75], 0
    v_mfma_f32_32x32x16_bf16 v[80:95], v[24:27], v[76:79], v[80:95]
    s_nop 11
    v_exp_f32 v80, v80
    v_exp_f32 v81, v81
    v_exp_f32 v82, v82
    v_exp_f32 v83, v83
    v_exp_f32 v84, v84
    v_exp_f32 v85, v85
    v_exp_f32 v86, v86
    v_exp_f32 v87, v87
    v_exp_f32 v88, v88
    v_exp_f32 v89, v89
    v_exp_f32 v90, v90
    v_exp_f32 v91, v91
    v_exp_f32 v92, v92
    v_exp_f32 v93, v93
    v_exp_f32 v94, v94
    v_exp_f32 v95, v95
    s_nop 0
    v_cvt_pk_bf16_f32 v36, v80, v81
    v_cvt_pk_bf16_f32 v37, v82, v83
    v_cvt_pk_bf16_f32 v38, v84, v85
    v_cvt_pk_bf16_f32 v39, v86, v87
    v_cvt_pk_bf16_f32 v40, v88, v89
    v_cvt_pk_bf16_f32 v41, v90, v91
    v_cvt_pk_bf16_f32 v42, v92, v93
    v_cvt_pk_bf16_f32 v43, v94, v95
    v_mfma_f32_32x32x16_bf16 v[96:111], v[28:31], v[36:39], v[96:111]
    s_nop 0
    v_mfma_f32_32x32x16_bf16 v[96:111], v[32:35], v[40:43], v[96:111]
    s_add_u32 s38, s38, 1
    s_and_b32 s42, s38, 3
    s_cmp_eq_u32 s42, 0
    s_cselect_b32 s42, 4096, 0
    s_add_u32 s42, s42, 256
    s_sub_u32 s38, s38, 1
    s_add_u32 s40, s40, s42
    s_add_u32 s41, s41, 1536
    s_add_u32 s38, s38, 1
    s_cmp_lt_u32 s38, 64
    s_cbranch_scc1 at_s2
    s_nop 0
    v_mov_b32 v48, v96
    v_mov_b32 v49, v97
    v_mov_b32 v50, v98
    v_mov_b32 v51, v99
    v_mov_b32 v52, v100
    v_mov_b32 v53, v101
    v_mov_b32 v54, v102
    v_mov_b32 v55, v103
    v_mov_b32 v56, v104
    v_mov_b32 v57, v105
    v_mov_b32 v58, v106
    v_mov_b32 v59, v107
    v_mov_b32 v122, v56
    v_mov_b32 v123, v56
    s_nop 1
    v_permlane32_swap_b32 v122, v123
    s_branch at_fin
y_g:
    s_sub_u32 s3, s2, 256
    s_setprio 0
    s_load_dwordx2 s[4:5], s[0:1], 0
    s_load_dwordx2 s[8:9], s[0:1], 32
    s_load_dwordx2 s[12:13], s[0:1], 40
    s_load_dwordx2 s[36:37], s[0:1], 80
    s_mov_b32 s6, 2621440
    s_mov_b32 s7, 0x20000
    s_mov_b32 s10, 2211840
    s_mov_b32 s11, 0x20000
    s_mov_b32 s14, 2211840
    s_mov_b32 s15, 0x20000
    s_mov_b32 s38, 24117248
    s_mov_b32 s39, 0x20000
    v_lshrrev_b32 v16, 6, v0
    v_and_b32 v1, 63, v0
    v_readfirstlane_b32 s16, v16
    s_and_b32 s22, s3, 7
    s_lshr_b32 s23, s3, 3
    s_and_b32 s17, s22, 3
    s_lshl_b32 s17, s17, 2
    s_and_b32 s24, s23, 3
    s_add_u32 s17, s17, s24
    s_lshr_b32 s18, s22, 2
    s_mul_i32 s18, s18, 7
    s_lshr_b32 s24, s23, 2
    s_cmp_eq_u32 s24, 7
    s_cbranch_scc1 y_gidle
    s_add_u32 s18, s18, s24
    s_mul_i32 s19, s17, 163840
    s_lshl_b32 s20, s18, 8
    s_lshl_b32 s21, s16, 11
    v_lshrrev_b32 v16, 3, v1
    s_lshl_b32 s22, s16, 4
    s_add_u32 s22, s22, 0
    v_add_u32 v16, s22, v16
    v_mul_u32_u24 v16, 1280, v16
    v_lshrrev_b32 v17, 4, v1
    v_add_u32 v17, 0, v17
    v_and_b32 v18, 7, v1
    v_xor_b32 v17, v17, v18
    v_lshlrev_b32 v17, 4, v17
    v_add_u32 v2, v16, v17
    v_lshrrev_b32 v16, 3, v1
    s_lshl_b32 s22, s16, 4
    s_add_u32 s22, s22, 8
    v_add_u32 v16, s22, v16
    v_mul_u32_u24 v16, 1280, v16
    v_lshrrev_b32 v17, 4, v1
    v_add_u32 v17, 4, v17
    v_and_b32 v18, 7, v1
    v_xor_b32 v17, v17, v18
    v_lshlrev_b32 v17, 4, v17
    v_add_u32 v3, v16, v17
    v_lshrrev_b32 v16, 4, v1
    s_lshl_b32 s22, s16, 2
    v_add_u32 v17, s22, v16
    v_mul_u32_u24 v17, 3456, v17
    v_bfe_u32 v18, v1, 1, 3
    v_lshlrev_b32 v19, 1, v16
    v_xor_b32 v18, v18, v19
    v_and_b32 v19, 1, v1
    v_lshlrev_b32 v19, 4, v19
    v_lshlrev_b32 v20, 5, v18
    v_add3_u32 v4, v17, v20, v19
    v_xor_b32 v18, 1, v18
    v_lshlrev_b32 v20, 5, v18
    v_add3_u32 v5, v17, v20, v19
    s_lshl_b32 s25, s16, 10
    s_lshr_b32 s22, s3, 3
    s_and_b32 s23, s22, 3
    s_mul_i32 s23, s23, 3
    s_lshr_b32 s22, s22, 2
    s_add_u32 s22, s22, s23
    s_add_u32 s22, s22, 5
    s_cmp_ge_u32 s22, 10
    s_cselect_b32 s23, 10, 0
    s_sub_u32 s22, s22, s23
    s_cmp_ge_u32 s22, 10
    s_cselect_b32 s23, 10, 0
    s_sub_u32 s22, s22, s23
    s_mul_i32 s22, s22, 1
    s_lshl_b32 s34, s22, 7
    s_mul_i32 s35, s22, 221184
    s_waitcnt lgkmcnt(0)
    s_mov_b32 s61, 18972672
    s_load_dword s60, s[58:59], s61
    s_waitcnt lgkmcnt(0)
    s_add_u32 s60, s60, 0x9e3779b9
    s_add_u32 s22, s19, s34
    s_add_u32 m0, s21, 0
    s_add_u32 s34, s34, 128
    buffer_load_dwordx4 v2, s[4:7], s22 offen lds
    s_add_u32 m0, s21, 1024
    s_cmp_eq_u32 s34, 1280
    buffer_load_dwordx4 v3, s[4:7], s22 offen lds
    s_cselect_b32 s34, 0, s34
    s_add_u32 s22, s20, s35
    s_add_u32 m0, s25, 32768
    s_add_u32 s35, s35, 110592
    buffer_load_dwordx4 v4, s[8:11], s22 offen lds
    s_add_u32 m0, s25, 40960
    s_cmp_eq_u32 s35, 2211840
    buffer_load_dwordx4 v5, s[12:15], s22 offen lds
    s_cselect_b32 s35, 0, s35
    s_add_u32 s22, s20, s35
    s_add_u32 m0, s25, 49152
    s_add_u32 s35, s35, 110592
    buffer_load_dwordx4 v4, s[8:11], s22 offen lds
    s_add_u32 m0, s25, 57344
    s_cmp_eq_u32 s35, 2211840
    buffer_load_dwordx4 v5, s[12:15], s22 offen lds
    s_cselect_b32 s35, 0, s35
    v_and_b32 v16, 31, v1
    v_lshrrev_b32 v17, 5, v1
    s_and_b32 s22, s16, 1
    s_lshl_b32 s22, s22, 13
    v_lshlrev_b32 v18, 7, v16
    v_add_u32 v18, s22, v18
    v_bfe_u32 v19, v1, 1, 3
    v_or_b32 v20, 0, v17
    v_xor_b32 v20, v20, v19
    v_lshlrev_b32 v20, 4, v20
    v_add_u32 v8, v18, v20
    v_or_b32 v20, 2, v17
    v_xor_b32 v20, v20, v19
    v_lshlrev_b32 v20, 4, v20
    v_add_u32 v9, v18, v20
    v_or_b32 v20, 4, v17
    v_xor_b32 v20, v20, v19
    v_lshlrev_b32 v20, 4, v20
    v_add_u32 v10, v18, v20
    v_or_b32 v20, 6, v17
    v_xor_b32 v20, v20, v19
    v_lshlrev_b32 v20, 4, v20
    v_add_u32 v11, v18, v20
    v_bfe_u32 v16, v1, 2, 2
    v_lshrrev_b32 v17, 5, v1
    v_lshlrev_b32 v17, 3, v17
    v_add_u32 v17, v17, v16
    v_lshlrev_b32 v17, 8, v17
    v_bfe_u32 v19, v1, 4, 1
    v_lshlrev_b32 v21, 13, v19
    v_add_u32 v17, v17, v21
    v_and_b32 v20, 3, v1
    v_lshlrev_b32 v20, 3, v20
    v_add_u32 v17, v17, v20
    v_lshlrev_b32 v18, 1, v16
    v_xor_b32 v18, v18, v19
    s_lshr_b32 s22, s16, 1
    s_lshl_b32 s22, s22, 1
    s_add_u32 s23, s22, 0
    v_xor_b32 v21, s23, v18
    v_lshlrev_b32 v21, 5, v21
    v_add_u32 v21, v21, v17
    v_add_u32 v12, 32768, v21
    s_add_u32 s23, s22, 1
    v_xor_b32 v21, s23, v18
    v_lshlrev_b32 v21, 5, v21
    v_add_u32 v21, v21, v17
    v_add_u32 v13, 32768, v21
    v_mov_b32 v32, 0
    v_mov_b32 v33, 0
    v_mov_b32 v34, 0
    v_mov_b32 v35, 0
    v_mov_b32 v36, 0
    v_mov_b32 v37, 0
    v_mov_b32 v38, 0
    v_mov_b32 v39, 0
    v_mov_b32 v40, 0
    v_mov_b32 v41, 0
    v_mov_b32 v42, 0
    v_mov_b32 v43, 0
    v_mov_b32 v44, 0
    v_mov_b32 v45, 0
    v_mov_b32 v46, 0
    v_mov_b32 v47, 0
    v_mov_b32 v48, 0
    v_mov_b32 v49, 0
    v_mov_b32 v50, 0
    v_mov_b32 v51, 0
    v_mov_b32 v52, 0
    v_mov_b32 v53, 0
    v_mov_b32 v54, 0
    v_mov_b32 v55, 0
    v_mov_b32 v56, 0
    v_mov_b32 v57, 0
    v_mov_b32 v58, 0
    v_mov_b32 v59, 0
    v_mov_b32 v60, 0
    v_mov_b32 v61, 0
    v_mov_b32 v62, 0
    v_mov_b32 v63, 0
    v_mov_b32 v64, 0
    v_mov_b32 v65, 0
    v_mov_b32 v66, 0
    v_mov_b32 v67, 0
    v_mov_b32 v68, 0
    v_mov_b32 v69, 0
    v_mov_b32 v70, 0
    v_mov_b32 v71, 0
    v_mov_b32 v72, 0
    v_mov_b32 v73, 0
    v_mov_b32 v74, 0
    v_mov_b32 v75, 0
    v_mov_b32 v76, 0
    v_mov_b32 v77, 0
    v_mov_b32 v78, 0
    v_mov_b32 v79, 0
    v_mov_b32 v80, 0
    v_mov_b32 v81, 0
    v_mov_b32 v82, 0
    v_mov_b32 v83, 0
    v_mov_b32 v84, 0
    v_mov_b32 v85, 0
    v_mov_b32 v86, 0
    v_mov_b32 v87, 0
    v_mov_b32 v88, 0
    v_mov_b32 v89, 0
    v_mov_b32 v90, 0
    v_mov_b32 v91, 0
    v_mov_b32 v92, 0
    v_mov_b32 v93, 0
    v_mov_b32 v94, 0
    v_mov_b32 v95, 0
    s_waitcnt vmcnt(2)
    s_barrier
    ds_read_b128 v[96:99], v8 offset:0
    ds_read_b128 v[100:103], v8 offset:4096
    ds_read_b64_tr_b16 v[104:105], v12 offset:0
    ds_read_b64_tr_b16 v[106:107], v12 offset:1024
    ds_read_b64_tr_b16 v[108:109], v13 offset:0
    ds_read_b64_tr_b16 v[110:111], v13 offset:1024
    ds_read_b128 v[112:115], v9 offset:0
    ds_read_b128 v[116:119], v9 offset:4096
    ds_read_b64_tr_b16 v[120:121], v12 offset:4096
    ds_read_b64_tr_b16 v[122:123], v12 offset:5120
    ds_read_b64_tr_b16 v[124:125], v13 offset:4096
    ds_read_b64_tr_b16 v[126:127], v13 offset:5120
    s_waitcnt lgkmcnt(6)
    v_mfma_f32_32x32x16_bf16 v[32:47], v[104:107], v[96:99], v[32:47]
    v_mfma_f32_32x32x16_bf16 v[48:63], v[108:111], v[96:99], v[48:63]
    v_mfma_f32_32x32x16_bf16 v[64:79], v[104:107], v[100:103], v[64:79]
    v_mfma_f32_32x32x16_bf16 v[80:95], v[108:111], v[100:103], v[80:95]
    s_add_u32 s22, s19, s34
    s_add_u32 m0, s21, 16384
    s_add_u32 s34, s34, 128
    buffer_load_dwordx4 v2, s[4:7], s22 offen lds
    s_add_u32 m0, s21, 17408
    s_cmp_eq_u32 s34, 1280
    buffer_load_dwordx4 v3, s[4:7], s22 offen lds
    s_cselect_b32 s34, 0, s34
    s_add_u32 s22, s20, s35
    s_add_u32 m0, s25, 65536
    s_add_u32 s35, s35, 110592
    buffer_load_dwordx4 v4, s[8:11], s22 offen lds
    s_add_u32 m0, s25, 73728
    s_cmp_eq_u32 s35, 2211840
    buffer_load_dwordx4 v5, s[12:15], s22 offen lds
    s_cselect_b32 s35, 0, s35
    s_waitcnt lgkmcnt(0)
    v_mfma_f32_32x32x16_bf16 v[32:47], v[120:123], v[112:115], v[32:47]
    v_mfma_f32_32x32x16_bf16 v[48:63], v[124:127], v[112:115], v[48:63]
    v_mfma_f32_32x32x16_bf16 v[64:79], v[120:123], v[116:119], v[64:79]
    v_mfma_f32_32x32x16_bf16 v[80:95], v[124:127], v[116:119], v[80:95]
    s_waitcnt vmcnt(4)
    s_barrier
    ds_read_b128 v[96:99], v10 offset:0
    ds_read_b128 v[100:103], v10 offset:4096
    ds_read_b64_tr_b16 v[104:105], v12 offset:16384
    ds_read_b64_tr_b16 v[106:107], v12 offset:17408
    ds_read_b64_tr_b16 v[108:109], v13 offset:16384
    ds_read_b64_tr_b16 v[110:111], v13 offset:17408
    ds_read_b128 v[112:115], v11 offset:0
    ds_read_b128 v[116:119], v11 offset:4096
    ds_read_b64_tr_b16 v[120:121], v12 offset:20480
    ds_read_b64_tr_b16 v[122:123], v12 offset:21504
    ds_read_b64_tr_b16 v[124:125], v13 offset:20480
    ds_read_b64_tr_b16 v[126:127], v13 offset:21504
    s_waitcnt lgkmcnt(6)
    v_mfma_f32_32x32x16_bf16 v[32:47], v[104:107], v[96:99], v[32:47]
    v_mfma_f32_32x32x16_bf16 v[48:63], v[108:111], v[96:99], v[48:63]
    v_mfma_f32_32x32x16_bf16 v[64:79], v[104:107], v[100:103], v[64:79]
    v_mfma_f32_32x32x16_bf16 v[80:95], v[108:111], v[100:103], v[80:95]
    s_add_u32 s22, s20, s35
    s_add_u32 m0, s25, 32768
    s_add_u32 s35, s35, 110592
    buffer_load_dwordx4 v4, s[8:11], s22 offen lds
    s_add_u32 m0, s25, 40960
    s_cmp_eq_u32 s35, 2211840
    buffer_load_dwordx4 v5, s[12:15], s22 offen lds
    s_cselect_b32 s35, 0, s35
    s_waitcnt lgkmcnt(0)
    v_mfma_f32_32x32x16_bf16 v[32:47], v[120:123], v[112:115], v[32:47]
    v_mfma_f32_32x32x16_bf16 v[48:63], v[124:127], v[112:115], v[48:63]
    v_mfma_f32_32x32x16_bf16 v[64:79], v[120:123], v[116:119], v[64:79]
    v_mfma_f32_32x32x16_bf16 v[80:95], v[124:127], v[116:119], v[80:95]
    s_waitcnt vmcnt(2)
    s_barrier
    ds_read_b128 v[96:99], v8 offset:16384
    ds_read_b128 v[100:103], v8 offset:20480
    ds_read_b64_tr_b16 v[104:105], v12 offset:32768
    ds_read_b64_tr_b16 v[106:107], v12 offset:33792
    ds_read_b64_tr_b16 v[108:109], v13 offset:32768
    ds_read_b64_tr_b16 v[110:111], v13 offset:33792
    ds_read_b128 v[112:115], v9 offset:16384
    ds_read_b128 v[116:119], v9 offset:20480
    ds_read_b64_tr_b16 v[120:121], v12 offset:36864
    ds_read_b64_tr_b16 v[122:123], v12 offset:37888
    ds_read_b64_tr_b16 v[124:125], v13 offset:36864
    ds_read_b64_tr_b16 v[126:127], v13 offset:37888
    s_waitcnt lgkmcnt(6)
    v_mfma_f32_32x32x16_bf16 v[32:47], v[104:107], v[96:99], v[32:47]
    v_mfma_f32_32x32x16_bf16 v[48:63], v[108:111], v[96:99], v[48:63]
    v_mfma_f32_32x32x16_bf16 v[64:79], v[104:107], v[100:103], v[64:79]
    v_mfma_f32_32x32x16_bf16 v[80:95], v[108:111], v[100:103], v[80:95]
    s_add_u32 s22, s19, s34
    s_add_u32 m0, s21, 0
    s_add_u32 s34, s34, 128
    buffer_load_dwordx4 v2, s[4:7], s22 offen lds
    s_add_u32 m0, s21, 1024
    s_cmp_eq_u32 s34, 1280
    buffer_load_dwordx4 v3, s[4:7], s22 offen lds
    s_cselect_b32 s34, 0, s34
    s_add_u32 s22, s20, s35
    s_add_u32 m0, s25, 49152
    s_add_u32 s35, s35, 110592
    buffer_load_dwordx4 v4, s[8:11], s22 offen lds
    s_add_u32 m0, s25, 57344
    s_cmp_eq_u32 s35, 2211840
    buffer_load_dwordx4 v5, s[12:15], s22 offen lds
    s_cselect_b32 s35, 0, s35
    s_waitcnt lgkmcnt(0)
    v_mfma_f32_32x32x16_bf16 v[32:47], v[120:123], v[112:115], v[32:47]
    v_mfma_f32_32x32x16_bf16 v[48:63], v[124:127], v[112:115], v[48:63]
    v_mfma_f32_32x32x16_bf16 v[64:79], v[120:123], v[116:119], v[64:79]
    v_mfma_f32_32x32x16_bf16 v[80:95], v[124:127], v[116:119], v[80:95]
    s_waitcnt vmcnt(4)
    s_barrier
    ds_read_b128 v[96:99], v10 offset:16384
    ds_read_b128 v[100:103], v10 offset:20480
    ds_read_b64_tr_b16 v[104:105], v12 offset:0
    ds_read_b64_tr_b16 v[106:107], v12 offset:1024
    ds_read_b64_tr_b16 v[108:109], v13 offset:0
    ds_read_b64_tr_b16 v[110:111], v13 offset:1024
    ds_read_b128 v[112:115], v11 offset:16384
    ds_read_b128 v[116:119], v11 offset:20480
    ds_read_b64_tr_b16 v[120:121], v12 offset:4096
    ds_read_b64_tr_b16 v[122:123], v12 offset:5120
    ds_read_b64_tr_b16 v[124:125], v13 offset:4096
    ds_read_b64_tr_b16 v[126:127], v13 offset:5120
    s_waitcnt lgkmcnt(6)
    v_mfma_f32_32x32x16_bf16 v[32:47], v[104:107], v[96:99], v[32:47]
    v_mfma_f32_32x32x16_bf16 v[48:63], v[108:111], v[96:99], v[48:63]
    v_mfma_f32_32x32x16_bf16 v[64:79], v[104:107], v[100:103], v[64:79]
    v_mfma_f32_32x32x16_bf16 v[80:95], v[108:111], v[100:103], v[80:95]
    s_add_u32 s22, s20, s35
    s_add_u32 m0, s25, 65536
    s_add_u32 s35, s35, 110592
    buffer_load_dwordx4 v4, s[8:11], s22 offen lds
    s_add_u32 m0, s25, 73728
    s_cmp_eq_u32 s35, 2211840
    buffer_load_dwordx4 v5, s[12:15], s22 offen lds
    s_cselect_b32 s35, 0, s35
    s_waitcnt lgkmcnt(0)
    v_mfma_f32_32x32x16_bf16 v[32:47], v[120:123], v[112:115], v[32:47]
    v_mfma_f32_32x32x16_bf16 v[48:63], v[124:127], v[112:115], v[48:63]
    v_mfma_f32_32x32x16_bf16 v[64:79], v[120:123], v[116:119], v[64:79]
    v_mfma_f32_32x32x16_bf16 v[80:95], v[124:127], v[116:119], v[80:95]
    s_waitcnt vmcnt(2)
    s_barrier
    ds_read_b128 v[96:99], v8 offset:0
    ds_read_b128 v[100:103], v8 offset:4096
    ds_read_b64_tr_b16 v[104:105], v12 offset:16384
    ds_read_b64_tr_b16 v[106:107], v12 offset:17408
    ds_read_b64_tr_b16 v[108:109], v13 offset:16384
    ds_read_b64_tr_b16 v[110:111], v13 offset:17408
    ds_read_b128 v[112:115], v9 offset:0
    ds_read_b128 v[116:119], v9 offset:4096
    ds_read_b64_tr_b16 v[120:121], v12 offset:20480
    ds_read_b64_tr_b16 v[122:123], v12 offset:21504
    ds_read_b64_tr_b16 v[124:125], v13 offset:20480
    ds_read_b64_tr_b16 v[126:127], v13 offset:21504
    s_waitcnt lgkmcnt(6)
    v_mfma_f32_32x32x16_bf16 v[32:47], v[104:107], v[96:99], v[32:47]
    v_mfma_f32_32x32x16_bf16 v[48:63], v[108:111], v[96:99], v[48:63]
    v_mfma_f32_32x32x16_bf16 v[64:79], v[104:107], v[100:103], v[64:79]
    v_mfma_f32_32x32x16_bf16 v[80:95], v[108:111], v[100:103], v[80:95]
    s_add_u32 s22, s19, s34
    s_add_u32 m0, s21, 16384
    s_add_u32 s34, s34, 128
    buffer_load_dwordx4 v2, s[4:7], s22 offen lds
    s_add_u32 m0, s21, 17408
    s_cmp_eq_u32 s34, 1280
    buffer_load_dwordx4 v3, s[4:7], s22 offen lds
    s_cselect_b32 s34, 0, s34
    s_add_u32 s22, s20, s35
    s_add_u32 m0, s25, 32768
    s_add_u32 s35, s35, 110592
    buffer_load_dwordx4 v4, s[8:11], s22 offen lds
    s_add_u32 m0, s25, 40960
    s_cmp_eq_u32 s35, 2211840
    buffer_load_dwordx4 v5, s[12:15], s22 offen lds
    s_cselect_b32 s35, 0, s35
    s_waitcnt lgkmcnt(0)
    v_mfma_f32_32x32x16_bf16 v[32:47], v[120:123], v[112:115], v[32:47]
    v_mfma_f32_32x32x16_bf16 v[48:63], v[124:127], v[112:115], v[48:63]
    v_mfma_f32_32x32x16_bf16 v[64:79], v[120:123], v[116:119], v[64:79]
    v_mfma_f32_32x32x16_bf16 v[80:95], v[124:127], v[116:119], v[80:95]
    s_waitcnt vmcnt(4)
    s_barrier
    ds_read_b128 v[96:99], v10 offset:0
    ds_read_b128 v[100:103], v10 offset:4096
    ds_read_b64_tr_b16 v[104:105], v12 offset:32768
    ds_read_b64_tr_b16 v[106:107], v12 offset:33792
    ds_read_b64_tr_b16 v[108:109], v13 offset:32768
    ds_read_b64_tr_b16 v[110:111], v13 offset:33792
    ds_read_b128 v[112:115], v11 offset:0
    ds_read_b128 v[116:119], v11 offset:4096
    ds_read_b64_tr_b16 v[120:121], v12 offset:36864
    ds_read_b64_tr_b16 v[122:123], v12 offset:37888
    ds_read_b64_tr_b16 v[124:125], v13 offset:36864
    ds_read_b64_tr_b16 v[126:127], v13 offset:37888
    s_waitcnt lgkmcnt(6)
    v_mfma_f32_32x32x16_bf16 v[32:47], v[104:107], v[96:99], v[32:47]
    v_mfma_f32_32x32x16_bf16 v[48:63], v[108:111], v[96:99], v[48:63]
    v_mfma_f32_32x32x16_bf16 v[64:79], v[104:107], v[100:103], v[64:79]
    v_mfma_f32_32x32x16_bf16 v[80:95], v[108:111], v[100:103], v[80:95]
    s_add_u32 s22, s20, s35
    s_add_u32 m0, s25, 49152
    s_add_u32 s35, s35, 110592
    buffer_load_dwordx4 v4, s[8:11], s22 offen lds
    s_add_u32 m0, s25, 57344
    s_cmp_eq_u32 s35, 2211840
    buffer_load_dwordx4 v5, s[12:15], s22 offen lds
    s_cselect_b32 s35, 0, s35
    s_waitcnt lgkmcnt(0)
    v_mfma_f32_32x32x16_bf16 v[32:47], v[120:123], v[112:115], v[32:47]
    v_mfma_f32_32x32x16_bf16 v[48:63], v[124:127], v[112:115], v[48:63]
    v_mfma_f32_32x32x16_bf16 v[64:79], v[120:123], v[116:119], v[64:79]
    v_mfma_f32_32x32x16_bf16 v[80:95], v[124:127], v[116:119], v[80:95]
    s_waitcnt vmcnt(2)
    s_barrier
    ds_read_b128 v[96:99], v8 offset:16384
    ds_read_b128 v[100:103], v8 offset:20480
    ds_read_b64_tr_b16 v[104:105], v12 offset:0
    ds_read_b64_tr_b16 v[106:107], v12 offset:1024
    ds_read_b64_tr_b16 v[108:109], v13 offset:0
    ds_read_b64_tr_b16 v[110:111], v13 offset:1024
    ds_read_b128 v[112:115], v9 offset:16384
    ds_read_b128 v[116:119], v9 offset:20480
    ds_read_b64_tr_b16 v[120:121], v12 offset:4096
    ds_read_b64_tr_b16 v[122:123], v12 offset:5120
    ds_read_b64_tr_b16 v[124:125], v13 offset:4096
    ds_read_b64_tr_b16 v[126:127], v13 offset:5120
    s_waitcnt lgkmcnt(6)
    v_mfma_f32_32x32x16_bf16 v[32:47], v[104:107], v[96:99], v[32:47]
    v_mfma_f32_32x32x16_bf16 v[48:63], v[108:111], v[96:99], v[48:63]
    v_mfma_f32_32x32x16_bf16 v[64:79], v[104:107], v[100:103], v[64:79]
    v_mfma_f32_32x32x16_bf16 v[80:95], v[108:111], v[100:103], v[80:95]
    s_add_u32 s22, s19, s34
    s_add_u32 m0, s21, 0
    s_add_u32 s34, s34, 128
    buffer_load_dwordx4 v2, s[4:7], s22 offen lds
    s_add_u32 m0, s21, 1024
    s_cmp_eq_u32 s34, 1280
    buffer_load_dwordx4 v3, s[4:7], s22 offen lds
    s_cselect_b32 s34, 0, s34
    s_add_u32 s22, s20, s35
    s_add_u32 m0, s25, 65536
    s_add_u32 s35, s35, 110592
    buffer_load_dwordx4 v4, s[8:11], s22 offen lds
    s_add_u32 m0, s25, 73728
    s_cmp_eq_u32 s35, 2211840
    buffer_load_dwordx4 v5, s[12:15], s22 offen lds
    s_cselect_b32 s35, 0, s35
    s_waitcnt lgkmcnt(0)
    v_mfma_f32_32x32x16_bf16 v[32:47], v[120:123], v[112:115], v[32:47]
    v_mfma_f32_32x32x16_bf16 v[48:63], v[124:127], v[112:115], v[48:63]
    v_mfma_f32_32x32x16_bf16 v[64:79], v[120:123], v[116:119], v[64:79]
    v_mfma_f32_32x32x16_bf16 v[80:95], v[124:127], v[116:119], v[80:95]
    s_waitcnt vmcnt(4)
    s_barrier
    ds_read_b128 v[96:99], v10 offset:16384
    ds_read_b128 v[100:103], v10 offset:20480
    ds_read_b64_tr_b16 v[104:105], v12 offset:16384
    ds_read_b64_tr_b16 v[106:107], v12 offset:17408
    ds_read_b64_tr_b16 v[108:109], v13 offset:16384
    ds_read_b64_tr_b16 v[110:111], v13 offset:17408
    ds_read_b128 v[112:115], v11 offset:16384
    ds_read_b128 v[116:119], v11 offset:20480
    ds_read_b64_tr_b16 v[120:121], v12 offset:20480
    ds_read_b64_tr_b16 v[122:123], v12 offset:21504
    ds_read_b64_tr_b16 v[124:125], v13 offset:20480
    ds_read_b64_tr_b16 v[126:127], v13 offset:21504
    s_waitcnt lgkmcnt(6)
    v_mfma_f32_32x32x16_bf16 v[32:47], v[104:107], v[96:99], v[32:47]
    v_mfma_f32_32x32x16_bf16 v[48:63], v[108:111], v[96:99], v[48:63]
    v_mfma_f32_32x32x16_bf16 v[64:79], v[104:107], v[100:103], v[64:79]
    v_mfma_f32_32x32x16_bf16 v[80:95], v[108:111], v[100:103], v[80:95]
    s_add_u32 s22, s20, s35
    s_add_u32 m0, s25, 32768
    s_add_u32 s35, s35, 110592
    buffer_load_dwordx4 v4, s[8:11], s22 offen lds
    s_add_u32 m0, s25, 40960
    s_cmp_eq_u32 s35, 2211840
    buffer_load_dwordx4 v5, s[12:15], s22 offen lds
    s_cselect_b32 s35, 0, s35
    s_waitcnt lgkmcnt(0)
    v_mfma_f32_32x32x16_bf16 v[32:47], v[120:123], v[112:115], v[32:47]
    v_mfma_f32_32x32x16_bf16 v[48:63], v[124:127], v[112:115], v[48:63]
    v_mfma_f32_32x32x16_bf16 v[64:79], v[120:123], v[116:119], v[64:79]
    v_mfma_f32_32x32x16_bf16 v[80:95], v[124:127], v[116:119], v[80:95]
    s_waitcnt vmcnt(2)
    s_barrier
    ds_read_b128 v[96:99], v8 offset:0
    ds_read_b128 v[100:103], v8 offset:4096
    ds_read_b64_tr_b16 v[104:105], v12 offset:32768
    ds_read_b64_tr_b16 v[106:107], v12 offset:33792
    ds_read_b64_tr_b16 v[108:109], v13 offset:32768
    ds_read_b64_tr_b16 v[110:111], v13 offset:33792
    ds_read_b128 v[112:115], v9 offset:0
    ds_read_b128 v[116:119], v9 offset:4096
    ds_read_b64_tr_b16 v[120:121], v12 offset:36864
    ds_read_b64_tr_b16 v[122:123], v12 offset:37888
    ds_read_b64_tr_b16 v[124:125], v13 offset:36864
    ds_read_b64_tr_b16 v[126:127], v13 offset:37888
    s_waitcnt lgkmcnt(6)
    v_mfma_f32_32x32x16_bf16 v[32:47], v[104:107], v[96:99], v[32:47]
    v_mfma_f32_32x32x16_bf16 v[48:63], v[108:111], v[96:99], v[48:63]
    v_mfma_f32_32x32x16_bf16 v[64:79], v[104:107], v[100:103], v[64:79]
    v_mfma_f32_32x32x16_bf16 v[80:95], v[108:111], v[100:103], v[80:95]
    s_add_u32 s22, s19, s34
    s_add_u32 m0, s21, 16384
    s_add_u32 s34, s34, 128
    buffer_load_dwordx4 v2, s[4:7], s22 offen lds
    s_add_u32 m0, s21, 17408
    s_cmp_eq_u32 s34, 1280
    buffer_load_dwordx4 v3, s[4:7], s22 offen lds
    s_cselect_b32 s34, 0, s34
    s_add_u32 s22, s20, s35
    s_add_u32 m0, s25, 49152
    s_add_u32 s35, s35, 110592
    buffer_load_dwordx4 v4, s[8:11], s22 offen lds
    s_add_u32 m0, s25, 57344
    s_cmp_eq_u32 s35, 2211840
    buffer_load_dwordx4 v5, s[12:15], s22 offen lds
    s_cselect_b32 s35, 0, s35
    s_waitcnt lgkmcnt(0)
    v_mfma_f32_32x32x16_bf16 v[32:47], v[120:123], v[112:115], v[32:47]
    v_mfma_f32_32x32x16_bf16 v[48:63], v[124:127], v[112:115], v[48:63]
    v_mfma_f32_32x32x16_bf16 v[64:79], v[120:123], v[116:119], v[64:79]
    v_mfma_f32_32x32x16_bf16 v[80:95], v[124:127], v[116:119], v[80:95]
    s_waitcnt vmcnt(4)
    s_barrier
    ds_read_b128 v[96:99], v10 offset:0
    ds_read_b128 v[100:103], v10 offset:4096
    ds_read_b64_tr_b16 v[104:105], v12 offset:0
    ds_read_b64_tr_b16 v[106:107], v12 offset:1024
    ds_read_b64_tr_b16 v[108:109], v13 offset:0
    ds_read_b64_tr_b16 v[110:111], v13 offset:1024
    ds_read_b128 v[112:115], v11 offset:0
    ds_read_b128 v[116:119], v11 offset:4096
    ds_read_b64_tr_b16 v[120:121], v12 offset:4096
    ds_read_b64_tr_b16 v[122:123], v12 offset:5120
    ds_read_b64_tr_b16 v[124:125], v13 offset:4096
    ds_read_b64_tr_b16 v[126:127], v13 offset:5120
    s_waitcnt lgkmcnt(6)
    v_mfma_f32_32x32x16_bf16 v[32:47], v[104:107], v[96:99], v[32:47]
    v_mfma_f32_32x32x16_bf16 v[48:63], v[108:111], v[96:99], v[48:63]
    v_mfma_f32_32x32x16_bf16 v[64:79], v[104:107], v[100:103], v[64:79]
    v_mfma_f32_32x32x16_bf16 v[80:95], v[108:111], v[100:103], v[80:95]
    s_add_u32 s22, s20, s35
    s_add_u32 m0, s25, 65536
    s_add_u32 s35, s35, 110592
    buffer_load_dwordx4 v4, s[8:11], s22 offen lds
    s_add_u32 m0, s25, 73728
    s_cmp_eq_u32 s35, 2211840
    buffer_load_dwordx4 v5, s[12:15], s22 offen lds
    s_cselect_b32 s35, 0, s35
    s_waitcnt lgkmcnt(0)
    v_mfma_f32_32x32x16_bf16 v[32:47], v[120:123], v[112:115], v[32:47]
    v_mfma_f32_32x32x16_bf16 v[48:63], v[124:127], v[112:115], v[48:63]
    v_mfma_f32_32x32x16_bf16 v[64:79], v[120:123], v[116:119], v[64:79]
    v_mfma_f32_32x32x16_bf16 v[80:95], v[124:127], v[116:119], v[80:95]
    s_waitcnt vmcnt(2)
    s_barrier
    ds_read_b128 v[96:99], v8 offset:16384
    ds_read_b128 v[100:103], v8 offset:20480
    ds_read_b64_tr_b16 v[104:105], v12 offset:16384
    ds_read_b64_tr_b16 v[106:107], v12 offset:17408
    ds_read_b64_tr_b16 v[108:109], v13 offset:16384
    ds_read_b64_tr_b16 v[110:111], v13 offset:17408
    ds_read_b128 v[112:115], v9 offset:16384
    ds_read_b128 v[116:119], v9 offset:20480
    ds_read_b64_tr_b16 v[120:121], v12 offset:20480
    ds_read_b64_tr_b16 v[122:123], v12 offset:21504
    ds_read_b64_tr_b16 v[124:125], v13 offset:20480
    ds_read_b64_tr_b16 v[126:127], v13 offset:21504
    s_waitcnt lgkmcnt(6)
    v_mfma_f32_32x32x16_bf16 v[32:47], v[104:107], v[96:99], v[32:47]
    v_mfma_f32_32x32x16_bf16 v[48:63], v[108:111], v[96:99], v[48:63]
    v_mfma_f32_32x32x16_bf16 v[64:79], v[104:107], v[100:103], v[64:79]
    v_mfma_f32_32x32x16_bf16 v[80:95], v[108:111], v[100:103], v[80:95]
    s_add_u32 s22, s19, s34
    s_add_u32 m0, s21, 0
    s_add_u32 s34, s34, 128
    buffer_load_dwordx4 v2, s[4:7], s22 offen lds
    s_add_u32 m0, s21, 1024
    s_cmp_eq_u32 s34, 1280
    buffer_load_dwordx4 v3, s[4:7], s22 offen lds
    s_cselect_b32 s34, 0, s34
    s_add_u32 s22, s20, s35
    s_add_u32 m0, s25, 32768
    s_add_u32 s35, s35, 110592
    buffer_load_dwordx4 v4, s[8:11], s22 offen lds
    s_add_u32 m0, s25, 40960
    s_cmp_eq_u32 s35, 2211840
    buffer_load_dwordx4 v5, s[12:15], s22 offen lds
    s_cselect_b32 s35, 0, s35
    s_waitcnt lgkmcnt(0)
    v_mfma_f32_32x32x16_bf16 v[32:47], v[120:123], v[112:115], v[32:47]
    v_mfma_f32_32x32x16_bf16 v[48:63], v[124:127], v[112:115], v[48:63]
    v_mfma_f32_32x32x16_bf16 v[64:79], v[120:123], v[116:119], v[64:79]
    v_mfma_f32_32x32x16_bf16 v[80:95], v[124:127], v[116:119], v[80:95]
    s_waitcnt vmcnt(4)
    s_barrier
    ds_read_b128 v[96:99], v10 offset:16384
    ds_read_b128 v[100:103], v10 offset:20480
    ds_read_b64_tr_b16 v[104:105], v12 offset:32768
    ds_read_b64_tr_b16 v[106:107], v12 offset:33792
    ds_read_b64_tr_b16 v[108:109], v13 offset:32768
    ds_read_b64_tr_b16 v[110:111], v13 offset:33792
    ds_read_b128 v[112:115], v11 offset:16384
    ds_read_b128 v[116:119], v11 offset:20480
    ds_read_b64_tr_b16 v[120:121], v12 offset:36864
    ds_read_b64_tr_b16 v[122:123], v12 offset:37888
    ds_read_b64_tr_b16 v[124:125], v13 offset:36864
    ds_read_b64_tr_b16 v[126:127], v13 offset:37888
    s_waitcnt lgkmcnt(6)
    v_mfma_f32_32x32x16_bf16 v[32:47], v[104:107], v[96:99], v[32:47]
    v_mfma_f32_32x32x16_bf16 v[48:63], v[108:111], v[96:99], v[48:63]
    v_mfma_f32_32x32x16_bf16 v[64:79], v[104:107], v[100:103], v[64:79]
    v_mfma_f32_32x32x16_bf16 v[80:95], v[108:111], v[100:103], v[80:95]
    s_add_u32 s22, s20, s35
    s_add_u32 m0, s25, 49152
    s_add_u32 s35, s35, 110592
    buffer_load_dwordx4 v4, s[8:11], s22 offen lds
    s_add_u32 m0, s25, 57344
    s_cmp_eq_u32 s35, 2211840
    buffer_load_dwordx4 v5, s[12:15], s22 offen lds
    s_cselect_b32 s35, 0, s35
    s_waitcnt lgkmcnt(0)
    v_mfma_f32_32x32x16_bf16 v[32:47], v[120:123], v[112:115], v[32:47]
    v_mfma_f32_32x32x16_bf16 v[48:63], v[124:127], v[112:115], v[48:63]
    v_mfma_f32_32x32x16_bf16 v[64:79], v[120:123], v[116:119], v[64:79]
    v_mfma_f32_32x32x16_bf16 v[80:95], v[124:127], v[116:119], v[80:95]
    s_waitcnt vmcnt(2)
    s_barrier
    ds_read_b128 v[96:99], v8 offset:0
    ds_read_b128 v[100:103], v8 offset:4096
    ds_read_b64_tr_b16 v[104:105], v12 offset:0
    ds_read_b64_tr_b16 v[106:107], v12 offset:1024
    ds_read_b64_tr_b16 v[108:109], v13 offset:0
    ds_read_b64_tr_b16 v[110:111], v13 offset:1024
    ds_read_b128 v[112:115], v9 offset:0
    ds_read_b128 v[116:119], v9 offset:4096
    ds_read_b64_tr_b16 v[120:121], v12 offset:4096
    ds_read_b64_tr_b16 v[122:123], v12 offset:5120
    ds_read_b64_tr_b16 v[124:125], v13 offset:4096
    ds_read_b64_tr_b16 v[126:127], v13 offset:5120
    s_waitcnt lgkmcnt(6)
    v_mfma_f32_32x32x16_bf16 v[32:47], v[104:107], v[96:99], v[32:47]
    v_mfma_f32_32x32x16_bf16 v[48:63], v[108:111], v[96:99], v[48:63]
    v_mfma_f32_32x32x16_bf16 v[64:79], v[104:107], v[100:103], v[64:79]
    v_mfma_f32_32x32x16_bf16 v[80:95], v[108:111], v[100:103], v[80:95]
    s_add_u32 s22, s19, s34
    s_add_u32 m0, s21, 16384
    s_add_u32 s34, s34, 128
    buffer_load_dwordx4 v2, s[4:7], s22 offen lds
    s_add_u32 m0, s21, 17408
    s_cmp_eq_u32 s34, 1280
    buffer_load_dwordx4 v3, s[4:7], s22 offen lds
    s_cselect_b32 s34, 0, s34
    s_add_u32 s22, s20, s35
    s_add_u32 m0, s25, 65536
    s_add_u32 s35, s35, 110592
    buffer_load_dwordx4 v4, s[8:11], s22 offen lds
    s_add_u32 m0, s25, 73728
    s_cmp_eq_u32 s35, 2211840
    buffer_load_dwordx4 v5, s[12:15], s22 offen lds
    s_cselect_b32 s35, 0, s35
    s_waitcnt lgkmcnt(0)
    v_mfma_f32_32x32x16_bf16 v[32:47], v[120:123], v[112:115], v[32:47]
    v_mfma_f32_32x32x16_bf16 v[48:63], v[124:127], v[112:115], v[48:63]
    v_mfma_f32_32x32x16_bf16 v[64:79], v[120:123], v[116:119], v[64:79]
    v_mfma_f32_32x32x16_bf16 v[80:95], v[124:127], v[116:119], v[80:95]
    s_waitcnt vmcnt(4)
    s_barrier
    ds_read_b128 v[96:99], v10 offset:0
    ds_read_b128 v[100:103], v10 offset:4096
    ds_read_b64_tr_b16 v[104:105], v12 offset:16384
    ds_read_b64_tr_b16 v[106:107], v12 offset:17408
    ds_read_b64_tr_b16 v[108:109], v13 offset:16384
    ds_read_b64_tr_b16 v[110:111], v13 offset:17408
    ds_read_b128 v[112:115], v11 offset:0
    ds_read_b128 v[116:119], v11 offset:4096
    ds_read_b64_tr_b16 v[120:121], v12 offset:20480
    ds_read_b64_tr_b16 v[122:123], v12 offset:21504
    ds_read_b64_tr_b16 v[124:125], v13 offset:20480
    ds_read_b64_tr_b16 v[126:127], v13 offset:21504
    s_waitcnt lgkmcnt(6)
    v_mfma_f32_32x32x16_bf16 v[32:47], v[104:107], v[96:99], v[32:47]
    v_mfma_f32_32x32x16_bf16 v[48:63], v[108:111], v[96:99], v[48:63]
    v_mfma_f32_32x32x16_bf16 v[64:79], v[104:107], v[100:103], v[64:79]
    v_mfma_f32_32x32x16_bf16 v[80:95], v[108:111], v[100:103], v[80:95]
    s_add_u32 s22, s20, s35
    s_add_u32 m0, s25, 32768
    s_add_u32 s35, s35, 110592
    buffer_load_dwordx4 v4, s[8:11], s22 offen lds
    s_add_u32 m0, s25, 40960
    s_cmp_eq_u32 s35, 2211840
    buffer_load_dwordx4 v5, s[12:15], s22 offen lds
    s_cselect_b32 s35, 0, s35
    s_waitcnt lgkmcnt(0)
    v_mfma_f32_32x32x16_bf16 v[32:47], v[120:123], v[112:115], v[32:47]
    v_mfma_f32_32x32x16_bf16 v[48:63], v[124:127], v[112:115], v[48:63]
    v_mfma_f32_32x32x16_bf16 v[64:79], v[120:123], v[116:119], v[64:79]
    v_mfma_f32_32x32x16_bf16 v[80:95], v[124:127], v[116:119], v[80:95]
    s_waitcnt vmcnt(2)
    s_barrier
    ds_read_b128 v[96:99], v8 offset:16384
    ds_read_b128 v[100:103], v8 offset:20480
    ds_read_b64_tr_b16 v[104:105], v12 offset:32768
    ds_read_b64_tr_b16 v[106:107], v12 offset:33792
    ds_read_b64_tr_b16 v[108:109], v13 offset:32768
    ds_read_b64_tr_b16 v[110:111], v13 offset:33792
    ds_read_b128 v[112:115], v9 offset:16384
    ds_read_b128 v[116:119], v9 offset:20480
    ds_read_b64_tr_b16 v[120:121], v12 offset:36864
    ds_read_b64_tr_b16 v[122:123], v12 offset:37888
    ds_read_b64_tr_b16 v[124:125], v13 offset:36864
    ds_read_b64_tr_b16 v[126:127], v13 offset:37888
    s_waitcnt lgkmcnt(6)
    v_mfma_f32_32x32x16_bf16 v[32:47], v[104:107], v[96:99], v[32:47]
    v_mfma_f32_32x32x16_bf16 v[48:63], v[108:111], v[96:99], v[48:63]
    v_mfma_f32_32x32x16_bf16 v[64:79], v[104:107], v[100:103], v[64:79]
    v_mfma_f32_32x32x16_bf16 v[80:95], v[108:111], v[100:103], v[80:95]
    s_add_u32 s22, s19, s34
    s_add_u32 m0, s21, 0
    s_add_u32 s34, s34, 128
    buffer_load_dwordx4 v2, s[4:7], s22 offen lds
    s_add_u32 m0, s21, 1024
    s_cmp_eq_u32 s34, 1280
    buffer_load_dwordx4 v3, s[4:7], s22 offen lds
    s_cselect_b32 s34, 0, s34
    s_add_u32 s22, s20, s35
    s_add_u32 m0, s25, 49152
    s_add_u32 s35, s35, 110592
    buffer_load_dwordx4 v4, s[8:11], s22 offen lds
    s_add_u32 m0, s25, 57344
    s_cmp_eq_u32 s35, 2211840
    buffer_load_dwordx4 v5, s[12:15], s22 offen lds
    s_cselect_b32 s35, 0, s35
    s_waitcnt lgkmcnt(0)
    v_mfma_f32_32x32x16_bf16 v[32:47], v[120:123], v[112:115], v[32:47]
    v_mfma_f32_32x32x16_bf16 v[48:63], v[124:127], v[112:115], v[48:63]
    v_mfma_f32_32x32x16_bf16 v[64:79], v[120:123], v[116:119], v[64:79]
    v_mfma_f32_32x32x16_bf16 v[80:95], v[124:127], v[116:119], v[80:95]
    s_waitcnt vmcnt(4)
    s_barrier
    ds_read_b128 v[96:99], v10 offset:16384
    ds_read_b128 v[100:103], v10 offset:20480
    ds_read_b64_tr_b16 v[104:105], v12 offset:0
    ds_read_b64_tr_b16 v[106:107], v12 offset:1024
    ds_read_b64_tr_b16 v[108:109], v13 offset:0
    ds_read_b64_tr_b16 v[110:111], v13 offset:1024
    ds_read_b128 v[112:115], v11 offset:16384
    ds_read_b128 v[116:119], v11 offset:20480
    ds_read_b64_tr_b16 v[120:121], v12 offset:4096
    ds_read_b64_tr_b16 v[122:123], v12 offset:5120
    ds_read_b64_tr_b16 v[124:125], v13 offset:4096
    ds_read_b64_tr_b16 v[126:127], v13 offset:5120
    s_waitcnt lgkmcnt(6)
    v_mfma_f32_32x32x16_bf16 v[32:47], v[104:107], v[96:99], v[32:47]
    v_mfma_f32_32x32x16_bf16 v[48:63], v[108:111], v[96:99], v[48:63]
    v_mfma_f32_32x32x16_bf16 v[64:79], v[104:107], v[100:103], v[64:79]
    v_mfma_f32_32x32x16_bf16 v[80:95], v[108:111], v[100:103], v[80:95]
    s_add_u32 s22, s20, s35
    s_add_u32 m0, s25, 65536
    s_add_u32 s35, s35, 110592
    buffer_load_dwordx4 v4, s[8:11], s22 offen lds
    s_add_u32 m0, s25, 73728
    s_cmp_eq_u32 s35, 2211840
    buffer_load_dwordx4 v5, s[12:15], s22 offen lds
    s_cselect_b32 s35, 0, s35
    s_waitcnt lgkmcnt(0)
    v_mfma_f32_32x32x16_bf16 v[32:47], v[120:123], v[112:115], v[32:47]
    v_mfma_f32_32x32x16_bf16 v[48:63], v[124:127], v[112:115], v[48:63]
    v_mfma_f32_32x32x16_bf16 v[64:79], v[120:123], v[116:119], v[64:79]
    v_mfma_f32_32x32x16_bf16 v[80:95], v[124:127], v[116:119], v[80:95]
    s_waitcnt vmcnt(2)
    s_barrier
    ds_read_b128 v[96:99], v8 offset:0
    ds_read_b128 v[100:103], v8 offset:4096
    ds_read_b64_tr_b16 v[104:105], v12 offset:16384
    ds_read_b64_tr_b16 v[106:107], v12 offset:17408
    ds_read_b64_tr_b16 v[108:109], v13 offset:16384
    ds_read_b64_tr_b16 v[110:111], v13 offset:17408
    ds_read_b128 v[112:115], v9 offset:0
    ds_read_b128 v[116:119], v9 offset:4096
    ds_read_b64_tr_b16 v[120:121], v12 offset:20480
    ds_read_b64_tr_b16 v[122:123], v12 offset:21504
    ds_read_b64_tr_b16 v[124:125], v13 offset:20480
    ds_read_b64_tr_b16 v[126:127], v13 offset:21504
    s_waitcnt lgkmcnt(6)
    v_mfma_f32_32x32x16_bf16 v[32:47], v[104:107], v[96:99], v[32:47]
    v_mfma_f32_32x32x16_bf16 v[48:63], v[108:111], v[96:99], v[48:63]
    v_mfma_f32_32x32x16_bf16 v[64:79], v[104:107], v[100:103], v[64:79]
    v_mfma_f32_32x32x16_bf16 v[80:95], v[108:111], v[100:103], v[80:95]
    s_add_u32 s22, s19, s34
    s_add_u32 m0, s21, 16384
    s_add_u32 s34, s34, 128
    buffer_load_dwordx4 v2, s[4:7], s22 offen lds
    s_add_u32 m0, s21, 17408
    s_cmp_eq_u32 s34, 1280
    buffer_load_dwordx4 v3, s[4:7], s22 offen lds
    s_cselect_b32 s34, 0, s34
    s_add_u32 s22, s20, s35
    s_add_u32 m0, s25, 32768
    s_add_u32 s35, s35, 110592
    buffer_load_dwordx4 v4, s[8:11], s22 offen lds
    s_add_u32 m0, s25, 40960
    s_cmp_eq_u32 s35, 2211840
    buffer_load_dwordx4 v5, s[12:15], s22 offen lds
    s_cselect_b32 s35, 0, s35
    s_waitcnt lgkmcnt(0)
    v_mfma_f32_32x32x16_bf16 v[32:47], v[120:123], v[112:115], v[32:47]
    v_mfma_f32_32x32x16_bf16 v[48:63], v[124:127], v[112:115], v[48:63]
    v_mfma_f32_32x32x16_bf16 v[64:79], v[120:123], v[116:119], v[64:79]
    v_mfma_f32_32x32x16_bf16 v[80:95], v[124:127], v[116:119], v[80:95]
    s_waitcnt vmcnt(4)
    s_barrier
    ds_read_b128 v[96:99], v10 offset:0
    ds_read_b128 v[100:103], v10 offset:4096
    ds_read_b64_tr_b16 v[104:105], v12 offset:32768
    ds_read_b64_tr_b16 v[106:107], v12 offset:33792
    ds_read_b64_tr_b16 v[108:109], v13 offset:32768
    ds_read_b64_tr_b16 v[110:111], v13 offset:33792
    ds_read_b128 v[112:115], v11 offset:0
    ds_read_b128 v[116:119], v11 offset:4096
    ds_read_b64_tr_b16 v[120:121], v12 offset:36864
    ds_read_b64_tr_b16 v[122:123], v12 offset:37888
    ds_read_b64_tr_b16 v[124:125], v13 offset:36864
    ds_read_b64_tr_b16 v[126:127], v13 offset:37888
    s_waitcnt lgkmcnt(6)
    v_mfma_f32_32x32x16_bf16 v[32:47], v[104:107], v[96:99], v[32:47]
    v_mfma_f32_32x32x16_bf16 v[48:63], v[108:111], v[96:99], v[48:63]
    v_mfma_f32_32x32x16_bf16 v[64:79], v[104:107], v[100:103], v[64:79]
    v_mfma_f32_32x32x16_bf16 v[80:95], v[108:111], v[100:103], v[80:95]
    s_add_u32 s22, s20, s35
    s_add_u32 m0, s25, 49152
    s_add_u32 s35, s35, 110592
    buffer_load_dwordx4 v4, s[8:11], s22 offen lds
    s_add_u32 m0, s25, 57344
    s_cmp_eq_u32 s35, 2211840
    buffer_load_dwordx4 v5, s[12:15], s22 offen lds
    s_cselect_b32 s35, 0, s35
    s_waitcnt lgkmcnt(0)
    v_mfma_f32_32x32x16_bf16 v[32:47], v[120:123], v[112:115], v[32:47]
    v_mfma_f32_32x32x16_bf16 v[48:63], v[124:127], v[112:115], v[48:63]
    v_mfma_f32_32x32x16_bf16 v[64:79], v[120:123], v[116:119], v[64:79]
    v_mfma_f32_32x32x16_bf16 v[80:95], v[124:127], v[116:119], v[80:95]
    s_waitcnt vmcnt(2)
    s_barrier
    ds_read_b128 v[96:99], v8 offset:16384
    ds_read_b128 v[100:103], v8 offset:20480
    ds_read_b64_tr_b16 v[104:105], v12 offset:0
    ds_read_b64_tr_b16 v[106:107], v12 offset:1024
    ds_read_b64_tr_b16 v[108:109], v13 offset:0
    ds_read_b64_tr_b16 v[110:111], v13 offset:1024
    ds_read_b128 v[112:115], v9 offset:16384
    ds_read_b128 v[116:119], v9 offset:20480
    ds_read_b64_tr_b16 v[120:121], v12 offset:4096
    ds_read_b64_tr_b16 v[122:123], v12 offset:5120
    ds_read_b64_tr_b16 v[124:125], v13 offset:4096
    ds_read_b64_tr_b16 v[126:127], v13 offset:5120
    s_waitcnt lgkmcnt(6)
    v_mfma_f32_32x32x16_bf16 v[32:47], v[104:107], v[96:99], v[32:47]
    v_mfma_f32_32x32x16_bf16 v[48:63], v[108:111], v[96:99], v[48:63]
    v_mfma_f32_32x32x16_bf16 v[64:79], v[104:107], v[100:103], v[64:79]
    v_mfma_f32_32x32x16_bf16 v[80:95], v[108:111], v[100:103], v[80:95]
    s_waitcnt lgkmcnt(0)
    v_mfma_f32_32x32x16_bf16 v[32:47], v[120:123], v[112:115], v[32:47]
    v_mfma_f32_32x32x16_bf16 v[48:63], v[124:127], v[112:115], v[48:63]
    v_mfma_f32_32x32x16_bf16 v[64:79], v[120:123], v[116:119], v[64:79]
    v_mfma_f32_32x32x16_bf16 v[80:95], v[124:127], v[116:119], v[80:95]
    s_waitcnt vmcnt(0)
    s_barrier
    ds_read_b128 v[96:99], v10 offset:16384
    ds_read_b128 v[100:103], v10 offset:20480
    ds_read_b64_tr_b16 v[104:105], v12 offset:16384
    ds_read_b64_tr_b16 v[106:107], v12 offset:17408
    ds_read_b64_tr_b16 v[108:109], v13 offset:16384
    ds_read_b64_tr_b16 v[110:111], v13 offset:17408
    ds_read_b128 v[112:115], v11 offset:16384
    ds_read_b128 v[116:119], v11 offset:20480
    ds_read_b64_tr_b16 v[120:121], v12 offset:20480
    ds_read_b64_tr_b16 v[122:123], v12 offset:21504
    ds_read_b64_tr_b16 v[124:125], v13 offset:20480
    ds_read_b64_tr_b16 v[126:127], v13 offset:21504
    s_waitcnt lgkmcnt(6)
    v_mfma_f32_32x32x16_bf16 v[32:47], v[104:107], v[96:99], v[32:47]
    v_mfma_f32_32x32x16_bf16 v[48:63], v[108:111], v[96:99], v[48:63]
    v_mfma_f32_32x32x16_bf16 v[64:79], v[104:107], v[100:103], v[64:79]
    v_mfma_f32_32x32x16_bf16 v[80:95], v[108:111], v[100:103], v[80:95]
    s_waitcnt lgkmcnt(0)
    v_mfma_f32_32x32x16_bf16 v[32:47], v[120:123], v[112:115], v[32:47]
    v_mfma_f32_32x32x16_bf16 v[48:63], v[124:127], v[112:115], v[48:63]
    v_mfma_f32_32x32x16_bf16 v[64:79], v[120:123], v[116:119], v[64:79]
    v_mfma_f32_32x32x16_bf16 v[80:95], v[124:127], v[116:119], v[80:95]
    s_setprio 3
    s_lshr_b32 s22, s16, 1
    s_lshl_b32 s22, s22, 1
    s_lshl_b32 s23, s18, 3
    s_add_u32 s23, s23, s22
    s_cmp_ge_u32 s23, 108
    s_cbranch_scc1 g1_skip
    s_and_b32 s22, s16, 1
    s_lshl_b32 s22, s22, 1
    s_lshl_b32 s24, s17, 2
    s_add_u32 s24, s24, s22
    s_mul_i32 s24, s24, 108
    s_add_u32 s24, s24, s23
    s_lshl_b32 s24, s24, 10
    s_add_u32 s24, s24, 8388608
    v_lshlrev_b32 v16, 4, v1
    s_mov_b32 s26, 3216550459
    v_mul_f32 v96, s26, v32
    v_mul_f32 v97, s26, v33
    v_mul_f32 v98, s26, v34
    v_mul_f32 v99, s26, v35
    v_mul_f32 v100, s26, v36
    v_mul_f32 v101, s26, v37
    v_mul_f32 v102, s26, v38
    v_mul_f32 v103, s26, v39
    v_exp_f32 v96, v96
    v_exp_f32 v97, v97
    v_exp_f32 v98, v98
    v_exp_f32 v99, v99
    v_exp_f32 v100, v100
    v_exp_f32 v101, v101
    v_exp_f32 v102, v102
    v_exp_f32 v103, v103
    v_add_f32 v96, 1.0, v96
    v_add_f32 v97, 1.0, v97
    v_add_f32 v98, 1.0, v98
    v_add_f32 v99, 1.0, v99
    v_add_f32 v100, 1.0, v100
    v_add_f32 v101, 1.0, v101
    v_add_f32 v102, 1.0, v102
    v_add_f32 v103, 1.0, v103
    v_rcp_f32 v96, v96
    v_rcp_f32 v97, v97
    v_rcp_f32 v98, v98
    v_rcp_f32 v99, v99
    v_rcp_f32 v100, v100
    v_rcp_f32 v101, v101
    v_rcp_f32 v102, v102
    v_rcp_f32 v103, v103
    v_mul_f32 v32, v32, v40
    v_mul_f32 v33, v33, v41
    v_mul_f32 v34, v34, v42
    v_mul_f32 v35, v35, v43
    v_mul_f32 v36, v36, v44
    v_mul_f32 v37, v37, v45
    v_mul_f32 v38, v38, v46
    v_mul_f32 v39, v39, v47
    v_mul_f32 v32, v32, v96
    v_mul_f32 v33, v33, v97
    v_mul_f32 v34, v34, v98
    v_mul_f32 v35, v35, v99
    v_mul_f32 v36, v36, v100
    v_mul_f32 v37, v37, v101
    v_mul_f32 v38, v38, v102
    v_mul_f32 v39, v39, v103
    v_cvt_pk_bf16_f32 v112, v32, v33
    v_cvt_pk_bf16_f32 v113, v34, v35
    v_cvt_pk_bf16_f32 v114, v36, v37
    v_cvt_pk_bf16_f32 v115, v38, v39
    s_add_u32 s22, s24, 0
    buffer_store_dwordx4 v[112:115], v16, s[36:39], s22 offen sc1
    v_mul_f32 v96, s26, v48
    v_mul_f32 v97, s26, v49
    v_mul_f32 v98, s26, v50
    v_mul_f32 v99, s26, v51
    v_mul_f32 v100, s26, v52
    v_mul_f32 v101, s26, v53
    v_mul_f32 v102, s26, v54
    v_mul_f32 v103, s26, v55
    v_exp_f32 v96, v96
    v_exp_f32 v97, v97
    v_exp_f32 v98, v98
    v_exp_f32 v99, v99
    v_exp_f32 v100, v100
    v_exp_f32 v101, v101
    v_exp_f32 v102, v102
    v_exp_f32 v103, v103
    v_add_f32 v96, 1.0, v96
    v_add_f32 v97, 1.0, v97
    v_add_f32 v98, 1.0, v98
    v_add_f32 v99, 1.0, v99
    v_add_f32 v100, 1.0, v100
    v_add_f32 v101, 1.0, v101
    v_add_f32 v102, 1.0, v102
    v_add_f32 v103, 1.0, v103
    v_rcp_f32 v96, v96
    v_rcp_f32 v97, v97
    v_rcp_f32 v98, v98
    v_rcp_f32 v99, v99
    v_rcp_f32 v100, v100
    v_rcp_f32 v101, v101
    v_rcp_f32 v102, v102
    v_rcp_f32 v103, v103
    v_mul_f32 v48, v48, v56
    v_mul_f32 v49, v49, v57
    v_mul_f32 v50, v50, v58
    v_mul_f32 v51, v51, v59
    v_mul_f32 v52, v52, v60
    v_mul_f32 v53, v53, v61
    v_mul_f32 v54, v54, v62
    v_mul_f32 v55, v55, v63
    v_mul_f32 v48, v48, v96
    v_mul_f32 v49, v49, v97
    v_mul_f32 v50, v50, v98
    v_mul_f32 v51, v51, v99
    v_mul_f32 v52, v52, v100
    v_mul_f32 v53, v53, v101
    v_mul_f32 v54, v54, v102
    v_mul_f32 v55, v55, v103
    v_cvt_pk_bf16_f32 v116, v48, v49
    v_cvt_pk_bf16_f32 v117, v50, v51
    v_cvt_pk_bf16_f32 v118, v52, v53
    v_cvt_pk_bf16_f32 v119, v54, v55
    s_add_u32 s22, s24, 1024
    buffer_store_dwordx4 v[116:119], v16, s[36:39], s22 offen sc1
    v_mul_f32 v96, s26, v64
    v_mul_f32 v97, s26, v65
    v_mul_f32 v98, s26, v66
    v_mul_f32 v99, s26, v67
    v_mul_f32 v100, s26, v68
    v_mul_f32 v101, s26, v69
    v_mul_f32 v102, s26, v70
    v_mul_f32 v103, s26, v71
    v_exp_f32 v96, v96
    v_exp_f32 v97, v97
    v_exp_f32 v98, v98
    v_exp_f32 v99, v99
    v_exp_f32 v100, v100
    v_exp_f32 v101, v101
    v_exp_f32 v102, v102
    v_exp_f32 v103, v103
    v_add_f32 v96, 1.0, v96
    v_add_f32 v97, 1.0, v97
    v_add_f32 v98, 1.0, v98
    v_add_f32 v99, 1.0, v99
    v_add_f32 v100, 1.0, v100
    v_add_f32 v101, 1.0, v101
    v_add_f32 v102, 1.0, v102
    v_add_f32 v103, 1.0, v103
    v_rcp_f32 v96, v96
    v_rcp_f32 v97, v97
    v_rcp_f32 v98, v98
    v_rcp_f32 v99, v99
    v_rcp_f32 v100, v100
    v_rcp_f32 v101, v101
    v_rcp_f32 v102, v102
    v_rcp_f32 v103, v103
    v_mul_f32 v64, v64, v72
    v_mul_f32 v65, v65, v73
    v_mul_f32 v66, v66, v74
    v_mul_f32 v67, v67, v75
    v_mul_f32 v68, v68, v76
    v_mul_f32 v69, v69, v77
    v_mul_f32 v70, v70, v78
    v_mul_f32 v71, v71, v79
    v_mul_f32 v64, v64, v96
    v_mul_f32 v65, v65, v97
    v_mul_f32 v66, v66, v98
    v_mul_f32 v67, v67, v99
    v_mul_f32 v68, v68, v100
    v_mul_f32 v69, v69, v101
    v_mul_f32 v70, v70, v102
    v_mul_f32 v71, v71, v103
    v_cvt_pk_bf16_f32 v112, v64, v65
    v_cvt_pk_bf16_f32 v113, v66, v67
    v_cvt_pk_bf16_f32 v114, v68, v69
    v_cvt_pk_bf16_f32 v115, v70, v71
    s_add_u32 s22, s24, 110592
    buffer_store_dwordx4 v[112:115], v16, s[36:39], s22 offen sc1
    v_mul_f32 v96, s26, v80
    v_mul_f32 v97, s26, v81
    v_mul_f32 v98, s26, v82
    v_mul_f32 v99, s26, v83
    v_mul_f32 v100, s26, v84
    v_mul_f32 v101, s26, v85
    v_mul_f32 v102, s26, v86
    v_mul_f32 v103, s26, v87
    v_exp_f32 v96, v96
    v_exp_f32 v97, v97
    v_exp_f32 v98, v98
    v_exp_f32 v99, v99
    v_exp_f32 v100, v100
    v_exp_f32 v101, v101
    v_exp_f32 v102, v102
    v_exp_f32 v103, v103
    v_add_f32 v96, 1.0, v96
    v_add_f32 v97, 1.0, v97
    v_add_f32 v98, 1.0, v98
    v_add_f32 v99, 1.0, v99
    v_add_f32 v100, 1.0, v100
    v_add_f32 v101, 1.0, v101
    v_add_f32 v102, 1.0, v102
    v_add_f32 v103, 1.0, v103
    v_rcp_f32 v96, v96
    v_rcp_f32 v97, v97
    v_rcp_f32 v98, v98
    v_rcp_f32 v99, v99
    v_rcp_f32 v100, v100
    v_rcp_f32 v101, v101
    v_rcp_f32 v102, v102
    v_rcp_f32 v103, v103
    v_mul_f32 v80, v80, v88
    v_mul_f32 v81, v81, v89
    v_mul_f32 v82, v82, v90
    v_mul_f32 v83, v83, v91
    v_mul_f32 v84, v84, v92
    v_mul_f32 v85, v85, v93
    v_mul_f32 v86, v86, v94
    v_mul_f32 v87, v87, v95
    v_mul_f32 v80, v80, v96
    v_mul_f32 v81, v81, v97
    v_mul_f32 v82, v82, v98
    v_mul_f32 v83, v83, v99
    v_mul_f32 v84, v84, v100
    v_mul_f32 v85, v85, v101
    v_mul_f32 v86, v86, v102
    v_mul_f32 v87, v87, v103
    v_cvt_pk_bf16_f32 v116, v80, v81
    v_cvt_pk_bf16_f32 v117, v82, v83
    v_cvt_pk_bf16_f32 v118, v84, v85
    v_cvt_pk_bf16_f32 v119, v86, v87
    s_add_u32 s22, s24, 111616
    buffer_store_dwordx4 v[116:119], v16, s[36:39], s22 offen sc1
g1_skip:
    s_setprio 0
    s_waitcnt vmcnt(0)
    s_barrier
    s_cmp_eq_u32 s16, 0
    s_cbranch_scc0 g1_sig
    s_mul_i32 s50, s17, 4352
    s_lshl_b32 s51, s18, 2
    s_add_u32 s50, s50, s51
    s_add_u32 s50, s50, 20482048
    v_mov_b32 v126, s60
    v_mov_b32 v127, 0
    s_mov_b64 exec, 1
    buffer_store_dword v126, v127, s[36:39], s50 offen sc1
    s_mov_b64 exec, -1
g1_sig:
    s_branch y_g2
y_gidle:
    s_waitcnt lgkmcnt(0)
    s_mov_b32 s61, 18972672
    s_load_dword s60, s[58:59], s61
    s_waitcnt lgkmcnt(0)
    s_add_u32 s60, s60, 0x9e3779b9
    s_cmp_eq_u32 s16, 0
    s_cbranch_scc0 gi_done
    s_and_b32 s50, s3, 3
    s_lshl_b32 s50, s50, 2
    s_lshr_b32 s51, s3, 3
    s_and_b32 s51, s51, 3
    s_add_u32 s50, s50, s51
    s_mul_i32 s50, s50, 4352
    s_bfe_u32 s51, s3, 0x10002
    s_add_u32 s51, s51, 14
    s_lshl_b32 s51, s51, 2
    s_add_u32 s50, s50, s51
    s_add_u32 s50, s50, 20482048
    v_mov_b32 v126, s60
    v_mov_b32 v127, 0
    s_mov_b64 exec, 1
    buffer_store_dword v126, v127, s[36:39], s50 offen sc1
    s_mov_b64 exec, -1
gi_done:
y_g2:
    s_setprio 0
    v_lshrrev_b32 v12, 6, v0
    v_and_b32 v1, 63, v0
    v_readfirstlane_b32 s16, v12
    s_load_dwordx2 s[4:5], s[0:1], 48
    s_load_dwordx2 s[8:9], s[0:1], 16
    s_load_dwordx2 s[12:13], s[0:1], 80
    s_load_dwordx2 s[44:45], s[0:1], 64
    s_mov_b32 s6, 2211840
    s_mov_b32 s7, 0x20000
    s_mov_b32 s10, 819200
    s_mov_b32 s11, 0x20000
    s_mov_b32 s14, 24117248
    s_mov_b32 s15, 0x20000
    s_mov_b32 s46, 2621440
    s_mov_b32 s47, 0x20000
    s_waitcnt lgkmcnt(0)
    s_lshl_b32 s22, s16, 8
    s_add_u32 s22, s22, s3
    s_lshl_b32 s22, s22, 13
    v_lshlrev_b32 v30, 7, v1
    v_add_u32 v30, s22, v30
    v_subrev_u32 v29, 2211840, v30
    buffer_load_dword v31, v30, s[4:7], 0 offen
    buffer_load_dword v28, v29, s[8:11], 0 offen
    s_and_b32 s22, s3, 7
    s_lshr_b32 s23, s3, 3
    s_cmp_ge_u32 s23, 30
    s_cbranch_scc1 g2_done
    s_mul_i32 s24, s23, 52429
    s_lshr_b32 s24, s24, 18
    s_mul_i32 s17, s24, 5
    s_sub_u32 s18, s23, s17
    s_and_b32 s17, s22, 1
    s_mul_i32 s17, s17, 5
    s_add_u32 s18, s18, s17
    s_lshr_b32 s17, s22, 1
    s_mul_i32 s23, s17, 11
    s_add_u32 s23, s23, 1
    s_lshr_b32 s23, s23, 1
    s_add_u32 s22, s17, 1
    s_mul_i32 s22, s22, 11
    s_add_u32 s22, s22, 1
    s_lshr_b32 s22, s22, 1
    s_add_u32 s17, s23, s24
    s_cmp_ge_u32 s17, s22
    s_cbranch_scc1 g2_done
    s_and_b32 s19, s16, 1
    s_lshr_b32 s20, s16, 1
    s_lshl_b32 s21, s16, 11
    v_lshlrev_b32 v2, 4, v1
    v_lshrrev_b32 v12, 3, v1
    s_lshl_b32 s22, s16, 4
    s_add_u32 s22, s22, 0
    v_add_u32 v12, s22, v12
    v_mov_b32 v13, v12
    v_mul_u32_u24 v13, 1280, v13
    v_bfe_u32 v14, v1, 2, 1
    v_bfe_u32 v15, v12, 1, 1
    v_xor_b32 v14, v14, v15
    v_lshlrev_b32 v14, 6, v14
    v_and_b32 v15, 3, v1
    v_lshlrev_b32 v15, 4, v15
    v_add3_u32 v3, v13, v14, v15
    v_lshrrev_b32 v12, 3, v1
    s_lshl_b32 s22, s16, 4
    s_add_u32 s22, s22, 8
    v_add_u32 v12, s22, v12
    v_mov_b32 v13, v12
    v_mul_u32_u24 v13, 1280, v13
    v_bfe_u32 v14, v1, 2, 1
    v_bfe_u32 v15, v12, 1, 1
    v_xor_b32 v14, v14, v15
    v_lshlrev_b32 v14, 6, v14
    v_and_b32 v15, 3, v1
    v_lshlrev_b32 v15, 4, v15
    v_add3_u32 v4, v13, v14, v15
    s_lshl_b32 s26, s18, 7
    s_mul_i32 s25, s17, 331776
    s_add_u32 s25, s25, 8388608
    s_lshl_b32 s27, s16, 10
    s_mul_i32 s28, s17, 122880
    s_add_u32 s28, s28, s27
    s_add_u32 s28, s28, 15728640
    s_lshr_b32 s22, s3, 3
    s_mul_i32 s23, s22, 52429
    s_lshr_b32 s23, s23, 18
    s_mul_i32 s24, s23, 5
    s_sub_u32 s24, s22, s24
    s_mul_i32 s24, s24, 3
    s_mul_i32 s23, s23, 5
    s_add_u32 s22, s23, s24
    s_mul_i32 s23, s22, 4682
    s_lshr_b32 s23, s23, 16
    s_mul_i32 s23, s23, 14
    s_sub_u32 s34, s22, s23
    s_mul_i32 s34, s34, 1
    s_cmp_eq_u32 s16, 0
    s_cbranch_scc0 g2_wh_join
    s_mul_i32 s50, s17, 96
    s_add_u32 s52, s50, 95
    s_min_u32 s52, s52, 2047
    s_lshr_b32 s50, s50, 7
    s_lshr_b32 s52, s52, 7
    v_mov_b32 v124, s50
    v_mov_b32 v125, s52
    v_bfe_u32 v126, v1, 4, 1
    v_cmp_eq_u32 vcc, 0, v126
    s_nop 1
    v_cndmask_b32 v124, v125, v124, vcc
    v_and_b32 v125, 15, v1
    v_mul_u32_u24 v126, 4352, v124
    v_lshl_add_u32 v126, v125, 2, v126
    v_add_u32 v126, 20482048, v126
    s_and_b32 s52, s3, 7
    s_mul_i32 s52, s52, 69888
    s_add_u32 s52, s52, 19988224
    v_lshlrev_b32 v124, 2, v124
    v_add_u32 v124, s52, v124
    v_cmp_lt_u32 vcc, 13, v125
    s_nop 1
    v_cndmask_b32 v126, v126, v124, vcc
    v_cmp_lt_u32 vcc, 31, v1
    s_nop 1
    v_cndmask_b32 v127, v126, v124, vcc
    s_mov_b32 s51, 100000
g2_wh_poll:
    buffer_load_dword v124, v127, s[12:15], 0 offen sc1
    s_waitcnt vmcnt(0)
    v_cmp_ne_u32 vcc, s60, v124
    s_nop 1
    s_cmp_eq_u64 vcc, 0
    s_cbranch_scc1 g2_wh_ok
    s_sleep 8
    s_sub_u32 s51, s51, 1
    s_cmp_lg_u32 s51, 0
    s_cbranch_scc1 g2_wh_poll
g2_wh_ok:
g2_wh_join:
    s_barrier
    v_and_b32 v12, 31, v1
    v_lshlrev_b32 v12, 2, v12
    s_mul_i32 s22, s17, 384
    s_add_u32 s22, s22, 18874368
    buffer_load_dword v8, v12, s[12:15], s22 offen offset:0 sc1
    buffer_load_dword v9, v12, s[12:15], s22 offen offset:128 sc1
    buffer_load_dword v10, v12, s[12:15], s22 offen offset:256 sc1
    v_bfe_u32 v12, v1, 2, 2
    v_lshrrev_b32 v13, 5, v1
    v_lshlrev_b32 v13, 2, v13
    v_add_u32 v13, v13, v12
    v_lshlrev_b32 v13, 7, v13
    v_lshrrev_b32 v14, 1, v12
    v_xor_b32 v14, s19, v14
    v_lshlrev_b32 v14, 6, v14
    v_bfe_u32 v15, v1, 4, 1
    v_lshlrev_b32 v15, 5, v15
    v_and_b32 v16, 3, v1
    v_lshlrev_b32 v16, 3, v16
    v_add3_u32 v13, v13, v14, v15
    s_lshl_b32 s22, s20, 11
    v_add3_u32 v5, v13, v16, s22
    s_lshl_b32 s22, s20, 10
    s_add_u32 s22, s22, 16384
    v_add_u32 v6, s22, v2
    v_mov_b32 v32, 0
    v_mov_b32 v33, 0
    v_mov_b32 v34, 0
    v_mov_b32 v35, 0
    v_mov_b32 v36, 0
    v_mov_b32 v37, 0
    v_mov_b32 v38, 0
    v_mov_b32 v39, 0
    v_mov_b32 v40, 0
    v_mov_b32 v41, 0
    v_mov_b32 v42, 0
    v_mov_b32 v43, 0
    v_mov_b32 v44, 0
    v_mov_b32 v45, 0
    v_mov_b32 v46, 0
    v_mov_b32 v47, 0
    v_mov_b32 v48, 0
    v_mov_b32 v49, 0
    v_mov_b32 v50, 0
    v_mov_b32 v51, 0
    v_mov_b32 v52, 0
    v_mov_b32 v53, 0
    v_mov_b32 v54, 0
    v_mov_b32 v55, 0
    v_mov_b32 v56, 0
    v_mov_b32 v57, 0
    v_mov_b32 v58, 0
    v_mov_b32 v59, 0
    v_mov_b32 v60, 0
    v_mov_b32 v61, 0
    v_mov_b32 v62, 0
    v_mov_b32 v63, 0
    v_mov_b32 v64, 0
    v_mov_b32 v65, 0
    v_mov_b32 v66, 0
    v_mov_b32 v67, 0
    v_mov_b32 v68, 0
    v_mov_b32 v69, 0
    v_mov_b32 v70, 0
    v_mov_b32 v71, 0
    v_mov_b32 v72, 0
    v_mov_b32 v73, 0
    v_mov_b32 v74, 0
    v_mov_b32 v75, 0
    v_mov_b32 v76, 0
    v_mov_b32 v77, 0
    v_mov_b32 v78, 0
    v_mov_b32 v79, 0
    v_lshrrev_b32 v12, 3, v1
    s_lshl_b32 s22, s16, 3
    v_add_u32 v12, s22, v12
    v_mul_u32_u24 v13, 1280, v12
    v_bfe_u32 v14, v1, 2, 1
    v_bfe_u32 v15, v12, 1, 1
    v_xor_b32 v14, v14, v15
    v_lshlrev_b32 v14, 6, v14
    v_and_b32 v15, 3, v1
    v_lshlrev_b32 v15, 4, v15
    v_add3_u32 v3, v13, v14, v15
    v_subrev_u32 v6, 8192, v6
    v_add_u32 v7, 32768, v6
    s_lshr_b32 s22, s3, 3
    s_mul_i32 s23, s22, 52429
    s_lshr_b32 s23, s23, 18
    s_mul_i32 s24, s23, 5
    s_sub_u32 s24, s22, s24
    s_mul_i32 s24, s24, 5
    s_mul_i32 s23, s23, 4
    s_add_u32 s22, s23, s24
    s_mul_i32 s23, s22, 2428
    s_lshr_b32 s23, s23, 16
    s_mul_i32 s23, s23, 27
    s_sub_u32 s34, s22, s23
    s_mul_i32 s34, s34, 1
    s_lshr_b32 s22, s16, 2
    s_mul_i32 s36, s22, 110592
    s_and_b32 s23, s16, 3
    s_lshl_b32 s23, s23, 10
    s_add_u32 s36, s36, s23
    s_add_u32 s36, s36, s25
    s_lshl_b32 s37, s22, 12
    s_add_u32 s37, s37, s23
    s_add_u32 s37, s37, 8192
    s_mov_b32 s41, 15
    s_mul_i32 s23, s34, 81920
    s_add_u32 s23, s23, s26
    s_add_u32 m0, s27, 0
    s_lshl_b32 s24, s34, 12
    buffer_load_dwordx4 v3, s[4:7], s23 offen lds
    s_add_u32 m0, s37, 0
    s_add_u32 s22, s24, s36
    buffer_load_dwordx4 v2, s[12:15], s22 offen sc1 lds
    s_cmp_lt_u32 s16, 4
    s_cbranch_scc0 g2_d4_1
    s_add_u32 m0, s37, 8192
    s_add_u32 s22, s22, 221184
    buffer_load_dwordx4 v2, s[12:15], s22 offen sc1 lds
g2_d4_1:
    s_add_u32 s34, s34, 1
    s_cmp_eq_u32 s34, 27
    s_cselect_b32 s34, 0, s34
    s_mul_i32 s23, s34, 81920
    s_add_u32 s23, s23, s26
    s_add_u32 m0, s27, 20480
    s_lshl_b32 s24, s34, 12
    buffer_load_dwordx4 v3, s[4:7], s23 offen lds
    s_add_u32 m0, s37, 20480
    s_add_u32 s22, s24, s36
    buffer_load_dwordx4 v2, s[12:15], s22 offen sc1 lds
    s_cmp_lt_u32 s16, 4
    s_cbranch_scc0 g2_d4_2
    s_add_u32 m0, s37, 28672
    s_add_u32 s22, s22, 221184
    buffer_load_dwordx4 v2, s[12:15], s22 offen sc1 lds
g2_d4_2:
    s_add_u32 s34, s34, 1
    s_cmp_eq_u32 s34, 27
    s_cselect_b32 s34, 0, s34
    s_mul_i32 s23, s34, 81920
    s_add_u32 s23, s23, s26
    s_add_u32 m0, s27, 40960
    s_lshl_b32 s24, s34, 12
    buffer_load_dwordx4 v3, s[4:7], s23 offen lds
    s_add_u32 m0, s37, 40960
    s_add_u32 s22, s24, s36
    buffer_load_dwordx4 v2, s[12:15], s22 offen sc1 lds
    s_cmp_lt_u32 s16, 4
    s_cbranch_scc0 g2_d4_3
    s_add_u32 m0, s37, 49152
    s_add_u32 s22, s22, 221184
    buffer_load_dwordx4 v2, s[12:15], s22 offen sc1 lds
g2_d4_3:
    s_add_u32 s34, s34, 1
    s_cmp_eq_u32 s34, 27
    s_cselect_b32 s34, 0, s34
    s_setprio 0
    s_bitcmp1_b32 s41, s16
    s_cbranch_scc0 g2_w4_0a
    s_waitcnt vmcnt(6) lgkmcnt(0)
    s_branch g2_w4_0b
g2_w4_0a:
    s_waitcnt vmcnt(4) lgkmcnt(0)
g2_w4_0b:
    s_barrier
    ds_read_b64_tr_b16 v[80:81], v5 offset:0
    ds_read_b64_tr_b16 v[82:83], v5 offset:1024
    ds_read_b128 v[84:87], v6 offset:0
    ds_read_b128 v[88:91], v6 offset:4096
    ds_read_b128 v[92:95], v6 offset:8192
    s_mul_i32 s23, s34, 81920
    s_add_u32 s23, s23, s26
    s_add_u32 m0, s27, 61440
    s_lshl_b32 s24, s34, 12
    buffer_load_dwordx4 v3, s[4:7], s23 offen lds
    s_add_u32 m0, s37, 61440
    s_add_u32 s22, s24, s36
    buffer_load_dwordx4 v2, s[12:15], s22 offen sc1 lds
    s_cmp_lt_u32 s16, 4
    s_cbranch_scc0 g2_d4_4
    s_add_u32 m0, s37, 69632
    s_add_u32 s22, s22, 221184
    buffer_load_dwordx4 v2, s[12:15], s22 offen sc1 lds
g2_d4_4:
    s_add_u32 s34, s34, 1
    s_cmp_eq_u32 s34, 27
    s_cselect_b32 s34, 0, s34
    s_bitcmp1_b32 s41, s16
    s_cbranch_scc0 g2_w4_1a
    s_waitcnt vmcnt(6) lgkmcnt(0)
    s_branch g2_w4_1b
g2_w4_1a:
    s_waitcnt vmcnt(4) lgkmcnt(0)
g2_w4_1b:
    s_barrier
    ds_read_b64_tr_b16 v[96:97], v5 offset:20480
    ds_read_b64_tr_b16 v[98:99], v5 offset:21504
    ds_read_b128 v[100:103], v6 offset:20480
    ds_read_b128 v[104:107], v6 offset:24576
    ds_read_b128 v[108:111], v6 offset:28672
    v_mfma_f32_32x32x16_bf16 v[32:47], v[80:83], v[84:87], v[32:47]
    v_mfma_f32_32x32x16_bf16 v[48:63], v[80:83], v[88:91], v[48:63]
    v_mfma_f32_32x32x16_bf16 v[64:79], v[80:83], v[92:95], v[64:79]
    s_mul_i32 s23, s34, 81920
    s_add_u32 s23, s23, s26
    s_add_u32 m0, s27, 0
    s_lshl_b32 s24, s34, 12
    buffer_load_dwordx4 v3, s[4:7], s23 offen lds
    s_add_u32 m0, s37, 0
    s_add_u32 s22, s24, s36
    buffer_load_dwordx4 v2, s[12:15], s22 offen sc1 lds
    s_cmp_lt_u32 s16, 4
    s_cbranch_scc0 g2_d4_5
    s_add_u32 m0, s37, 8192
    s_add_u32 s22, s22, 221184
    buffer_load_dwordx4 v2, s[12:15], s22 offen sc1 lds
g2_d4_5:
    s_add_u32 s34, s34, 1
    s_cmp_eq_u32 s34, 27
    s_cselect_b32 s34, 0, s34
    s_bitcmp1_b32 s41, s16
    s_cbranch_scc0 g2_w4_2a
    s_waitcnt vmcnt(6) lgkmcnt(0)
    s_branch g2_w4_2b
g2_w4_2a:
    s_waitcnt vmcnt(4) lgkmcnt(0)
g2_w4_2b:
    s_barrier
    ds_read_b64_tr_b16 v[80:81], v5 offset:40960
    ds_read_b64_tr_b16 v[82:83], v5 offset:41984
    ds_read_b128 v[84:87], v7 offset:8192
    ds_read_b128 v[88:91], v7 offset:12288
    ds_read_b128 v[92:95], v7 offset:16384
    v_mfma_f32_32x32x16_bf16 v[32:47], v[96:99], v[100:103], v[32:47]
    v_mfma_f32_32x32x16_bf16 v[48:63], v[96:99], v[104:107], v[48:63]
    v_mfma_f32_32x32x16_bf16 v[64:79], v[96:99], v[108:111], v[64:79]
    s_mul_i32 s23, s34, 81920
    s_add_u32 s23, s23, s26
    s_add_u32 m0, s27, 20480
    s_lshl_b32 s24, s34, 12
    buffer_load_dwordx4 v3, s[4:7], s23 offen lds
    s_add_u32 m0, s37, 20480
    s_add_u32 s22, s24, s36
    buffer_load_dwordx4 v2, s[12:15], s22 offen sc1 lds
    s_cmp_lt_u32 s16, 4
    s_cbranch_scc0 g2_d4_6
    s_add_u32 m0, s37, 28672
    s_add_u32 s22, s22, 221184
    buffer_load_dwordx4 v2, s[12:15], s22 offen sc1 lds
g2_d4_6:
    s_add_u32 s34, s34, 1
    s_cmp_eq_u32 s34, 27
    s_cselect_b32 s34, 0, s34
    s_bitcmp1_b32 s41, s16
    s_cbranch_scc0 g2_w4_3a
    s_waitcnt vmcnt(6) lgkmcnt(0)
    s_branch g2_w4_3b
g2_w4_3a:
    s_waitcnt vmcnt(4) lgkmcnt(0)
g2_w4_3b:
    s_barrier
    ds_read_b64_tr_b16 v[96:97], v5 offset:61440
    ds_read_b64_tr_b16 v[98:99], v5 offset:62464
    ds_read_b128 v[100:103], v7 offset:28672
    ds_read_b128 v[104:107], v7 offset:32768
    ds_read_b128 v[108:111], v7 offset:36864
    v_mfma_f32_32x32x16_bf16 v[32:47], v[80:83], v[84:87], v[32:47]
    v_mfma_f32_32x32x16_bf16 v[48:63], v[80:83], v[88:91], v[48:63]
    v_mfma_f32_32x32x16_bf16 v[64:79], v[80:83], v[92:95], v[64:79]
    s_mul_i32 s23, s34, 81920
    s_add_u32 s23, s23, s26
    s_add_u32 m0, s27, 40960
    s_lshl_b32 s24, s34, 12
    buffer_load_dwordx4 v3, s[4:7], s23 offen lds
    s_add_u32 m0, s37, 40960
    s_add_u32 s22, s24, s36
    buffer_load_dwordx4 v2, s[12:15], s22 offen sc1 lds
    s_cmp_lt_u32 s16, 4
    s_cbranch_scc0 g2_d4_7
    s_add_u32 m0, s37, 49152
    s_add_u32 s22, s22, 221184
    buffer_load_dwordx4 v2, s[12:15], s22 offen sc1 lds
g2_d4_7:
    s_add_u32 s34, s34, 1
    s_cmp_eq_u32 s34, 27
    s_cselect_b32 s34, 0, s34
    s_bitcmp1_b32 s41, s16
    s_cbranch_scc0 g2_w4_4a
    s_waitcnt vmcnt(6) lgkmcnt(0)
    s_branch g2_w4_4b
g2_w4_4a:
    s_waitcnt vmcnt(4) lgkmcnt(0)
g2_w4_4b:
    s_barrier
    ds_read_b64_tr_b16 v[80:81], v5 offset:0
    ds_read_b64_tr_b16 v[82:83], v5 offset:1024
    ds_read_b128 v[84:87], v6 offset:0
    ds_read_b128 v[88:91], v6 offset:4096
    ds_read_b128 v[92:95], v6 offset:8192
    v_mfma_f32_32x32x16_bf16 v[32:47], v[96:99], v[100:103], v[32:47]
    v_mfma_f32_32x32x16_bf16 v[48:63], v[96:99], v[104:107], v[48:63]
    v_mfma_f32_32x32x16_bf16 v[64:79], v[96:99], v[108:111], v[64:79]
    s_mul_i32 s23, s34, 81920
    s_add_u32 s23, s23, s26
    s_add_u32 m0, s27, 61440
    s_lshl_b32 s24, s34, 12
    buffer_load_dwordx4 v3, s[4:7], s23 offen lds
    s_add_u32 m0, s37, 61440
    s_add_u32 s22, s24, s36
    buffer_load_dwordx4 v2, s[12:15], s22 offen sc1 lds
    s_cmp_lt_u32 s16, 4
    s_cbranch_scc0 g2_d4_8
    s_add_u32 m0, s37, 69632
    s_add_u32 s22, s22, 221184
    buffer_load_dwordx4 v2, s[12:15], s22 offen sc1 lds
g2_d4_8:
    s_add_u32 s34, s34, 1
    s_cmp_eq_u32 s34, 27
    s_cselect_b32 s34, 0, s34
    s_bitcmp1_b32 s41, s16
    s_cbranch_scc0 g2_w4_5a
    s_waitcnt vmcnt(6) lgkmcnt(0)
    s_branch g2_w4_5b
g2_w4_5a:
    s_waitcnt vmcnt(4) lgkmcnt(0)
g2_w4_5b:
    s_barrier
    ds_read_b64_tr_b16 v[96:97], v5 offset:20480
    ds_read_b64_tr_b16 v[98:99], v5 offset:21504
    ds_read_b128 v[100:103], v6 offset:20480
    ds_read_b128 v[104:107], v6 offset:24576
    ds_read_b128 v[108:111], v6 offset:28672
    v_mfma_f32_32x32x16_bf16 v[32:47], v[80:83], v[84:87], v[32:47]
    v_mfma_f32_32x32x16_bf16 v[48:63], v[80:83], v[88:91], v[48:63]
    v_mfma_f32_32x32x16_bf16 v[64:79], v[80:83], v[92:95], v[64:79]
    s_mul_i32 s23, s34, 81920
    s_add_u32 s23, s23, s26
    s_add_u32 m0, s27, 0
    s_lshl_b32 s24, s34, 12
    buffer_load_dwordx4 v3, s[4:7], s23 offen lds
    s_add_u32 m0, s37, 0
    s_add_u32 s22, s24, s36
    buffer_load_dwordx4 v2, s[12:15], s22 offen sc1 lds
    s_cmp_lt_u32 s16, 4
    s_cbranch_scc0 g2_d4_9
    s_add_u32 m0, s37, 8192
    s_add_u32 s22, s22, 221184
    buffer_load_dwordx4 v2, s[12:15], s22 offen sc1 lds
g2_d4_9:
    s_add_u32 s34, s34, 1
    s_cmp_eq_u32 s34, 27
    s_cselect_b32 s34, 0, s34
    s_bitcmp1_b32 s41, s16
    s_cbranch_scc0 g2_w4_6a
    s_waitcnt vmcnt(6) lgkmcnt(0)
    s_branch g2_w4_6b
g2_w4_6a:
    s_waitcnt vmcnt(4) lgkmcnt(0)
g2_w4_6b:
    s_barrier
    ds_read_b64_tr_b16 v[80:81], v5 offset:40960
    ds_read_b64_tr_b16 v[82:83], v5 offset:41984
    ds_read_b128 v[84:87], v7 offset:8192
    ds_read_b128 v[88:91], v7 offset:12288
    ds_read_b128 v[92:95], v7 offset:16384
    v_mfma_f32_32x32x16_bf16 v[32:47], v[96:99], v[100:103], v[32:47]
    v_mfma_f32_32x32x16_bf16 v[48:63], v[96:99], v[104:107], v[48:63]
    v_mfma_f32_32x32x16_bf16 v[64:79], v[96:99], v[108:111], v[64:79]
    s_mul_i32 s23, s34, 81920
    s_add_u32 s23, s23, s26
    s_add_u32 m0, s27, 20480
    s_lshl_b32 s24, s34, 12
    buffer_load_dwordx4 v3, s[4:7], s23 offen lds
    s_add_u32 m0, s37, 20480
    s_add_u32 s22, s24, s36
    buffer_load_dwordx4 v2, s[12:15], s22 offen sc1 lds
    s_cmp_lt_u32 s16, 4
    s_cbranch_scc0 g2_d4_10
    s_add_u32 m0, s37, 28672
    s_add_u32 s22, s22, 221184
    buffer_load_dwordx4 v2, s[12:15], s22 offen sc1 lds
g2_d4_10:
    s_add_u32 s34, s34, 1
    s_cmp_eq_u32 s34, 27
    s_cselect_b32 s34, 0, s34
    s_bitcmp1_b32 s41, s16
    s_cbranch_scc0 g2_w4_7a
    s_waitcnt vmcnt(6) lgkmcnt(0)
    s_branch g2_w4_7b
g2_w4_7a:
    s_waitcnt vmcnt(4) lgkmcnt(0)
g2_w4_7b:
    s_barrier
    ds_read_b64_tr_b16 v[96:97], v5 offset:61440
    ds_read_b64_tr_b16 v[98:99], v5 offset:62464
    ds_read_b128 v[100:103], v7 offset:28672
    ds_read_b128 v[104:107], v7 offset:32768
    ds_read_b128 v[108:111], v7 offset:36864
    v_mfma_f32_32x32x16_bf16 v[32:47], v[80:83], v[84:87], v[32:47]
    v_mfma_f32_32x32x16_bf16 v[48:63], v[80:83], v[88:91], v[48:63]
    v_mfma_f32_32x32x16_bf16 v[64:79], v[80:83], v[92:95], v[64:79]
    s_mul_i32 s23, s34, 81920
    s_add_u32 s23, s23, s26
    s_add_u32 m0, s27, 40960
    s_lshl_b32 s24, s34, 12
    buffer_load_dwordx4 v3, s[4:7], s23 offen lds
    s_add_u32 m0, s37, 40960
    s_add_u32 s22, s24, s36
    buffer_load_dwordx4 v2, s[12:15], s22 offen sc1 lds
    s_cmp_lt_u32 s16, 4
    s_cbranch_scc0 g2_d4_11
    s_add_u32 m0, s37, 49152
    s_add_u32 s22, s22, 221184
    buffer_load_dwordx4 v2, s[12:15], s22 offen sc1 lds
g2_d4_11:
    s_add_u32 s34, s34, 1
    s_cmp_eq_u32 s34, 27
    s_cselect_b32 s34, 0, s34
    s_bitcmp1_b32 s41, s16
    s_cbranch_scc0 g2_w4_8a
    s_waitcnt vmcnt(6) lgkmcnt(0)
    s_branch g2_w4_8b
g2_w4_8a:
    s_waitcnt vmcnt(4) lgkmcnt(0)
g2_w4_8b:
    s_barrier
    ds_read_b64_tr_b16 v[80:81], v5 offset:0
    ds_read_b64_tr_b16 v[82:83], v5 offset:1024
    ds_read_b128 v[84:87], v6 offset:0
    ds_read_b128 v[88:91], v6 offset:4096
    ds_read_b128 v[92:95], v6 offset:8192
    v_mfma_f32_32x32x16_bf16 v[32:47], v[96:99], v[100:103], v[32:47]
    v_mfma_f32_32x32x16_bf16 v[48:63], v[96:99], v[104:107], v[48:63]
    v_mfma_f32_32x32x16_bf16 v[64:79], v[96:99], v[108:111], v[64:79]
    s_mul_i32 s23, s34, 81920
    s_add_u32 s23, s23, s26
    s_add_u32 m0, s27, 61440
    s_lshl_b32 s24, s34, 12
    buffer_load_dwordx4 v3, s[4:7], s23 offen lds
    s_add_u32 m0, s37, 61440
    s_add_u32 s22, s24, s36
    buffer_load_dwordx4 v2, s[12:15], s22 offen sc1 lds
    s_cmp_lt_u32 s16, 4
    s_cbranch_scc0 g2_d4_12
    s_add_u32 m0, s37, 69632
    s_add_u32 s22, s22, 221184
    buffer_load_dwordx4 v2, s[12:15], s22 offen sc1 lds
g2_d4_12:
    s_add_u32 s34, s34, 1
    s_cmp_eq_u32 s34, 27
    s_cselect_b32 s34, 0, s34
    s_bitcmp1_b32 s41, s16
    s_cbranch_scc0 g2_w4_9a
    s_waitcnt vmcnt(6) lgkmcnt(0)
    s_branch g2_w4_9b
g2_w4_9a:
    s_waitcnt vmcnt(4) lgkmcnt(0)
g2_w4_9b:
    s_barrier
    ds_read_b64_tr_b16 v[96:97], v5 offset:20480
    ds_read_b64_tr_b16 v[98:99], v5 offset:21504
    ds_read_b128 v[100:103], v6 offset:20480
    ds_read_b128 v[104:107], v6 offset:24576
    ds_read_b128 v[108:111], v6 offset:28672
    v_mfma_f32_32x32x16_bf16 v[32:47], v[80:83], v[84:87], v[32:47]
    v_mfma_f32_32x32x16_bf16 v[48:63], v[80:83], v[88:91], v[48:63]
    v_mfma_f32_32x32x16_bf16 v[64:79], v[80:83], v[92:95], v[64:79]
    s_mul_i32 s23, s34, 81920
    s_add_u32 s23, s23, s26
    s_add_u32 m0, s27, 0
    s_lshl_b32 s24, s34, 12
    buffer_load_dwordx4 v3, s[4:7], s23 offen lds
    s_add_u32 m0, s37, 0
    s_add_u32 s22, s24, s36
    buffer_load_dwordx4 v2, s[12:15], s22 offen sc1 lds
    s_cmp_lt_u32 s16, 4
    s_cbranch_scc0 g2_d4_13
    s_add_u32 m0, s37, 8192
    s_add_u32 s22, s22, 221184
    buffer_load_dwordx4 v2, s[12:15], s22 offen sc1 lds
g2_d4_13:
    s_add_u32 s34, s34, 1
    s_cmp_eq_u32 s34, 27
    s_cselect_b32 s34, 0, s34
    s_bitcmp1_b32 s41, s16
    s_cbranch_scc0 g2_w4_10a
    s_waitcnt vmcnt(6) lgkmcnt(0)
    s_branch g2_w4_10b
g2_w4_10a:
    s_waitcnt vmcnt(4) lgkmcnt(0)
g2_w4_10b:
    s_barrier
    ds_read_b64_tr_b16 v[80:81], v5 offset:40960
    ds_read_b64_tr_b16 v[82:83], v5 offset:41984
    ds_read_b128 v[84:87], v7 offset:8192
    ds_read_b128 v[88:91], v7 offset:12288
    ds_read_b128 v[92:95], v7 offset:16384
    v_mfma_f32_32x32x16_bf16 v[32:47], v[96:99], v[100:103], v[32:47]
    v_mfma_f32_32x32x16_bf16 v[48:63], v[96:99], v[104:107], v[48:63]
    v_mfma_f32_32x32x16_bf16 v[64:79], v[96:99], v[108:111], v[64:79]
    s_mul_i32 s23, s34, 81920
    s_add_u32 s23, s23, s26
    s_add_u32 m0, s27, 20480
    s_lshl_b32 s24, s34, 12
    buffer_load_dwordx4 v3, s[4:7], s23 offen lds
    s_add_u32 m0, s37, 20480
    s_add_u32 s22, s24, s36
    buffer_load_dwordx4 v2, s[12:15], s22 offen sc1 lds
    s_cmp_lt_u32 s16, 4
    s_cbranch_scc0 g2_d4_14
    s_add_u32 m0, s37, 28672
    s_add_u32 s22, s22, 221184
    buffer_load_dwordx4 v2, s[12:15], s22 offen sc1 lds
g2_d4_14:
    s_add_u32 s34, s34, 1
    s_cmp_eq_u32 s34, 27
    s_cselect_b32 s34, 0, s34
    s_bitcmp1_b32 s41, s16
    s_cbranch_scc0 g2_w4_11a
    s_waitcnt vmcnt(6) lgkmcnt(0)
    s_branch g2_w4_11b
g2_w4_11a:
    s_waitcnt vmcnt(4) lgkmcnt(0)
g2_w4_11b:
    s_barrier
    ds_read_b64_tr_b16 v[96:97], v5 offset:61440
    ds_read_b64_tr_b16 v[98:99], v5 offset:62464
    ds_read_b128 v[100:103], v7 offset:28672
    ds_read_b128 v[104:107], v7 offset:32768
    ds_read_b128 v[108:111], v7 offset:36864
    v_mfma_f32_32x32x16_bf16 v[32:47], v[80:83], v[84:87], v[32:47]
    v_mfma_f32_32x32x16_bf16 v[48:63], v[80:83], v[88:91], v[48:63]
    v_mfma_f32_32x32x16_bf16 v[64:79], v[80:83], v[92:95], v[64:79]
    s_mul_i32 s23, s34, 81920
    s_add_u32 s23, s23, s26
    s_add_u32 m0, s27, 40960
    s_lshl_b32 s24, s34, 12
    buffer_load_dwordx4 v3, s[4:7], s23 offen lds
    s_add_u32 m0, s37, 40960
    s_add_u32 s22, s24, s36
    buffer_load_dwordx4 v2, s[12:15], s22 offen sc1 lds
    s_cmp_lt_u32 s16, 4
    s_cbranch_scc0 g2_d4_15
    s_add_u32 m0, s37, 49152
    s_add_u32 s22, s22, 221184
    buffer_load_dwordx4 v2, s[12:15], s22 offen sc1 lds
g2_d4_15:
    s_add_u32 s34, s34, 1
    s_cmp_eq_u32 s34, 27
    s_cselect_b32 s34, 0, s34
    s_bitcmp1_b32 s41, s16
    s_cbranch_scc0 g2_w4_12a
    s_waitcnt vmcnt(6) lgkmcnt(0)
    s_branch g2_w4_12b
g2_w4_12a:
    s_waitcnt vmcnt(4) lgkmcnt(0)
g2_w4_12b:
    s_barrier
    ds_read_b64_tr_b16 v[80:81], v5 offset:0
    ds_read_b64_tr_b16 v[82:83], v5 offset:1024
    ds_read_b128 v[84:87], v6 offset:0
    ds_read_b128 v[88:91], v6 offset:4096
    ds_read_b128 v[92:95], v6 offset:8192
    v_mfma_f32_32x32x16_bf16 v[32:47], v[96:99], v[100:103], v[32:47]
    v_mfma_f32_32x32x16_bf16 v[48:63], v[96:99], v[104:107], v[48:63]
    v_mfma_f32_32x32x16_bf16 v[64:79], v[96:99], v[108:111], v[64:79]
    s_mul_i32 s23, s34, 81920
    s_add_u32 s23, s23, s26
    s_add_u32 m0, s27, 61440
    s_lshl_b32 s24, s34, 12
    buffer_load_dwordx4 v3, s[4:7], s23 offen lds
    s_add_u32 m0, s37, 61440
    s_add_u32 s22, s24, s36
    buffer_load_dwordx4 v2, s[12:15], s22 offen sc1 lds
    s_cmp_lt_u32 s16, 4
    s_cbranch_scc0 g2_d4_16
    s_add_u32 m0, s37, 69632
    s_add_u32 s22, s22, 221184
    buffer_load_dwordx4 v2, s[12:15], s22 offen sc1 lds
g2_d4_16:
    s_add_u32 s34, s34, 1
    s_cmp_eq_u32 s34, 27
    s_cselect_b32 s34, 0, s34
    s_bitcmp1_b32 s41, s16
    s_cbranch_scc0 g2_w4_13a
    s_waitcnt vmcnt(6) lgkmcnt(0)
    s_branch g2_w4_13b
g2_w4_13a:
    s_waitcnt vmcnt(4) lgkmcnt(0)
g2_w4_13b:
    s_barrier
    ds_read_b64_tr_b16 v[96:97], v5 offset:20480
    ds_read_b64_tr_b16 v[98:99], v5 offset:21504
    ds_read_b128 v[100:103], v6 offset:20480
    ds_read_b128 v[104:107], v6 offset:24576
    ds_read_b128 v[108:111], v6 offset:28672
    v_mfma_f32_32x32x16_bf16 v[32:47], v[80:83], v[84:87], v[32:47]
    v_mfma_f32_32x32x16_bf16 v[48:63], v[80:83], v[88:91], v[48:63]
    v_mfma_f32_32x32x16_bf16 v[64:79], v[80:83], v[92:95], v[64:79]
    s_mul_i32 s23, s34, 81920
    s_add_u32 s23, s23, s26
    s_add_u32 m0, s27, 0
    s_lshl_b32 s24, s34, 12
    buffer_load_dwordx4 v3, s[4:7], s23 offen lds
    s_add_u32 m0, s37, 0
    s_add_u32 s22, s24, s36
    buffer_load_dwordx4 v2, s[12:15], s22 offen sc1 lds
    s_cmp_lt_u32 s16, 4
    s_cbranch_scc0 g2_d4_17
    s_add_u32 m0, s37, 8192
    s_add_u32 s22, s22, 221184
    buffer_load_dwordx4 v2, s[12:15], s22 offen sc1 lds
g2_d4_17:
    s_add_u32 s34, s34, 1
    s_cmp_eq_u32 s34, 27
    s_cselect_b32 s34, 0, s34
    s_bitcmp1_b32 s41, s16
    s_cbranch_scc0 g2_w4_14a
    s_waitcnt vmcnt(6) lgkmcnt(0)
    s_branch g2_w4_14b
g2_w4_14a:
    s_waitcnt vmcnt(4) lgkmcnt(0)
g2_w4_14b:
    s_barrier
    ds_read_b64_tr_b16 v[80:81], v5 offset:40960
    ds_read_b64_tr_b16 v[82:83], v5 offset:41984
    ds_read_b128 v[84:87], v7 offset:8192
    ds_read_b128 v[88:91], v7 offset:12288
    ds_read_b128 v[92:95], v7 offset:16384
    v_mfma_f32_32x32x16_bf16 v[32:47], v[96:99], v[100:103], v[32:47]
    v_mfma_f32_32x32x16_bf16 v[48:63], v[96:99], v[104:107], v[48:63]
    v_mfma_f32_32x32x16_bf16 v[64:79], v[96:99], v[108:111], v[64:79]
    s_mul_i32 s23, s34, 81920
    s_add_u32 s23, s23, s26
    s_add_u32 m0, s27, 20480
    s_lshl_b32 s24, s34, 12
    buffer_load_dwordx4 v3, s[4:7], s23 offen lds
    s_add_u32 m0, s37, 20480
    s_add_u32 s22, s24, s36
    buffer_load_dwordx4 v2, s[12:15], s22 offen sc1 lds
    s_cmp_lt_u32 s16, 4
    s_cbranch_scc0 g2_d4_18
    s_add_u32 m0, s37, 28672
    s_add_u32 s22, s22, 221184
    buffer_load_dwordx4 v2, s[12:15], s22 offen sc1 lds
g2_d4_18:
    s_add_u32 s34, s34, 1
    s_cmp_eq_u32 s34, 27
    s_cselect_b32 s34, 0, s34
    s_bitcmp1_b32 s41, s16
    s_cbranch_scc0 g2_w4_15a
    s_waitcnt vmcnt(6) lgkmcnt(0)
    s_branch g2_w4_15b
g2_w4_15a:
    s_waitcnt vmcnt(4) lgkmcnt(0)
g2_w4_15b:
    s_barrier
    ds_read_b64_tr_b16 v[96:97], v5 offset:61440
    ds_read_b64_tr_b16 v[98:99], v5 offset:62464
    ds_read_b128 v[100:103], v7 offset:28672
    ds_read_b128 v[104:107], v7 offset:32768
    ds_read_b128 v[108:111], v7 offset:36864
    v_mfma_f32_32x32x16_bf16 v[32:47], v[80:83], v[84:87], v[32:47]
    v_mfma_f32_32x32x16_bf16 v[48:63], v[80:83], v[88:91], v[48:63]
    v_mfma_f32_32x32x16_bf16 v[64:79], v[80:83], v[92:95], v[64:79]
    s_mul_i32 s23, s34, 81920
    s_add_u32 s23, s23, s26
    s_add_u32 m0, s27, 40960
    s_lshl_b32 s24, s34, 12
    buffer_load_dwordx4 v3, s[4:7], s23 offen lds
    s_add_u32 m0, s37, 40960
    s_add_u32 s22, s24, s36
    buffer_load_dwordx4 v2, s[12:15], s22 offen sc1 lds
    s_cmp_lt_u32 s16, 4
    s_cbranch_scc0 g2_d4_19
    s_add_u32 m0, s37, 49152
    s_add_u32 s22, s22, 221184
    buffer_load_dwordx4 v2, s[12:15], s22 offen sc1 lds
g2_d4_19:
    s_add_u32 s34, s34, 1
    s_cmp_eq_u32 s34, 27
    s_cselect_b32 s34, 0, s34
    s_bitcmp1_b32 s41, s16
    s_cbranch_scc0 g2_w4_16a
    s_waitcnt vmcnt(6) lgkmcnt(0)
    s_branch g2_w4_16b
g2_w4_16a:
    s_waitcnt vmcnt(4) lgkmcnt(0)
g2_w4_16b:
    s_barrier
    ds_read_b64_tr_b16 v[80:81], v5 offset:0
    ds_read_b64_tr_b16 v[82:83], v5 offset:1024
    ds_read_b128 v[84:87], v6 offset:0
    ds_read_b128 v[88:91], v6 offset:4096
    ds_read_b128 v[92:95], v6 offset:8192
    v_mfma_f32_32x32x16_bf16 v[32:47], v[96:99], v[100:103], v[32:47]
    v_mfma_f32_32x32x16_bf16 v[48:63], v[96:99], v[104:107], v[48:63]
    v_mfma_f32_32x32x16_bf16 v[64:79], v[96:99], v[108:111], v[64:79]
    s_mul_i32 s23, s34, 81920
    s_add_u32 s23, s23, s26
    s_add_u32 m0, s27, 61440
    s_lshl_b32 s24, s34, 12
    buffer_load_dwordx4 v3, s[4:7], s23 offen lds
    s_add_u32 m0, s37, 61440
    s_add_u32 s22, s24, s36
    buffer_load_dwordx4 v2, s[12:15], s22 offen sc1 lds
    s_cmp_lt_u32 s16, 4
    s_cbranch_scc0 g2_d4_20
    s_add_u32 m0, s37, 69632
    s_add_u32 s22, s22, 221184
    buffer_load_dwordx4 v2, s[12:15], s22 offen sc1 lds
g2_d4_20:
    s_add_u32 s34, s34, 1
    s_cmp_eq_u32 s34, 27
    s_cselect_b32 s34, 0, s34
    s_bitcmp1_b32 s41, s16
    s_cbranch_scc0 g2_w4_17a
    s_waitcnt vmcnt(6) lgkmcnt(0)
    s_branch g2_w4_17b
g2_w4_17a:
    s_waitcnt vmcnt(4) lgkmcnt(0)
g2_w4_17b:
    s_barrier
    ds_read_b64_tr_b16 v[96:97], v5 offset:20480
    ds_read_b64_tr_b16 v[98:99], v5 offset:21504
    ds_read_b128 v[100:103], v6 offset:20480
    ds_read_b128 v[104:107], v6 offset:24576
    ds_read_b128 v[108:111], v6 offset:28672
    v_mfma_f32_32x32x16_bf16 v[32:47], v[80:83], v[84:87], v[32:47]
    v_mfma_f32_32x32x16_bf16 v[48:63], v[80:83], v[88:91], v[48:63]
    v_mfma_f32_32x32x16_bf16 v[64:79], v[80:83], v[92:95], v[64:79]
    s_mul_i32 s23, s34, 81920
    s_add_u32 s23, s23, s26
    s_add_u32 m0, s27, 0
    s_lshl_b32 s24, s34, 12
    buffer_load_dwordx4 v3, s[4:7], s23 offen lds
    s_add_u32 m0, s37, 0
    s_add_u32 s22, s24, s36
    buffer_load_dwordx4 v2, s[12:15], s22 offen sc1 lds
    s_cmp_lt_u32 s16, 4
    s_cbranch_scc0 g2_d4_21
    s_add_u32 m0, s37, 8192
    s_add_u32 s22, s22, 221184
    buffer_load_dwordx4 v2, s[12:15], s22 offen sc1 lds
g2_d4_21:
    s_add_u32 s34, s34, 1
    s_cmp_eq_u32 s34, 27
    s_cselect_b32 s34, 0, s34
    s_bitcmp1_b32 s41, s16
    s_cbranch_scc0 g2_w4_18a
    s_waitcnt vmcnt(6) lgkmcnt(0)
    s_branch g2_w4_18b
g2_w4_18a:
    s_waitcnt vmcnt(4) lgkmcnt(0)
g2_w4_18b:
    s_barrier
    ds_read_b64_tr_b16 v[80:81], v5 offset:40960
    ds_read_b64_tr_b16 v[82:83], v5 offset:41984
    ds_read_b128 v[84:87], v7 offset:8192
    ds_read_b128 v[88:91], v7 offset:12288
    ds_read_b128 v[92:95], v7 offset:16384
    v_mfma_f32_32x32x16_bf16 v[32:47], v[96:99], v[100:103], v[32:47]
    v_mfma_f32_32x32x16_bf16 v[48:63], v[96:99], v[104:107], v[48:63]
    v_mfma_f32_32x32x16_bf16 v[64:79], v[96:99], v[108:111], v[64:79]
    s_mul_i32 s23, s34, 81920
    s_add_u32 s23, s23, s26
    s_add_u32 m0, s27, 20480
    s_lshl_b32 s24, s34, 12
    buffer_load_dwordx4 v3, s[4:7], s23 offen lds
    s_add_u32 m0, s37, 20480
    s_add_u32 s22, s24, s36
    buffer_load_dwordx4 v2, s[12:15], s22 offen sc1 lds
    s_cmp_lt_u32 s16, 4
    s_cbranch_scc0 g2_d4_22
    s_add_u32 m0, s37, 28672
    s_add_u32 s22, s22, 221184
    buffer_load_dwordx4 v2, s[12:15], s22 offen sc1 lds
g2_d4_22:
    s_add_u32 s34, s34, 1
    s_cmp_eq_u32 s34, 27
    s_cselect_b32 s34, 0, s34
    s_bitcmp1_b32 s41, s16
    s_cbranch_scc0 g2_w4_19a
    s_waitcnt vmcnt(6) lgkmcnt(0)
    s_branch g2_w4_19b
g2_w4_19a:
    s_waitcnt vmcnt(4) lgkmcnt(0)
g2_w4_19b:
    s_barrier
    ds_read_b64_tr_b16 v[96:97], v5 offset:61440
    ds_read_b64_tr_b16 v[98:99], v5 offset:62464
    ds_read_b128 v[100:103], v7 offset:28672
    ds_read_b128 v[104:107], v7 offset:32768
    ds_read_b128 v[108:111], v7 offset:36864
    v_mfma_f32_32x32x16_bf16 v[32:47], v[80:83], v[84:87], v[32:47]
    v_mfma_f32_32x32x16_bf16 v[48:63], v[80:83], v[88:91], v[48:63]
    v_mfma_f32_32x32x16_bf16 v[64:79], v[80:83], v[92:95], v[64:79]
    s_mul_i32 s23, s34, 81920
    s_add_u32 s23, s23, s26
    s_add_u32 m0, s27, 40960
    s_lshl_b32 s24, s34, 12
    buffer_load_dwordx4 v3, s[4:7], s23 offen lds
    s_add_u32 m0, s37, 40960
    s_add_u32 s22, s24, s36
    buffer_load_dwordx4 v2, s[12:15], s22 offen sc1 lds
    s_cmp_lt_u32 s16, 4
    s_cbranch_scc0 g2_d4_23
    s_add_u32 m0, s37, 49152
    s_add_u32 s22, s22, 221184
    buffer_load_dwordx4 v2, s[12:15], s22 offen sc1 lds
g2_d4_23:
    s_add_u32 s34, s34, 1
    s_cmp_eq_u32 s34, 27
    s_cselect_b32 s34, 0, s34
    s_bitcmp1_b32 s41, s16
    s_cbranch_scc0 g2_w4_20a
    s_waitcnt vmcnt(6) lgkmcnt(0)
    s_branch g2_w4_20b
g2_w4_20a:
    s_waitcnt vmcnt(4) lgkmcnt(0)
g2_w4_20b:
    s_barrier
    ds_read_b64_tr_b16 v[80:81], v5 offset:0
    ds_read_b64_tr_b16 v[82:83], v5 offset:1024
    ds_read_b128 v[84:87], v6 offset:0
    ds_read_b128 v[88:91], v6 offset:4096
    ds_read_b128 v[92:95], v6 offset:8192
    v_mfma_f32_32x32x16_bf16 v[32:47], v[96:99], v[100:103], v[32:47]
    v_mfma_f32_32x32x16_bf16 v[48:63], v[96:99], v[104:107], v[48:63]
    v_mfma_f32_32x32x16_bf16 v[64:79], v[96:99], v[108:111], v[64:79]
    s_mul_i32 s23, s34, 81920
    s_add_u32 s23, s23, s26
    s_add_u32 m0, s27, 61440
    s_lshl_b32 s24, s34, 12
    buffer_load_dwordx4 v3, s[4:7], s23 offen lds
    s_add_u32 m0, s37, 61440
    s_add_u32 s22, s24, s36
    buffer_load_dwordx4 v2, s[12:15], s22 offen sc1 lds
    s_cmp_lt_u32 s16, 4
    s_cbranch_scc0 g2_d4_24
    s_add_u32 m0, s37, 69632
    s_add_u32 s22, s22, 221184
    buffer_load_dwordx4 v2, s[12:15], s22 offen sc1 lds
g2_d4_24:
    s_add_u32 s34, s34, 1
    s_cmp_eq_u32 s34, 27
    s_cselect_b32 s34, 0, s34
    s_bitcmp1_b32 s41, s16
    s_cbranch_scc0 g2_w4_21a
    s_waitcnt vmcnt(6) lgkmcnt(0)
    s_branch g2_w4_21b
g2_w4_21a:
    s_waitcnt vmcnt(4) lgkmcnt(0)
g2_w4_21b:
    s_barrier
    ds_read_b64_tr_b16 v[96:97], v5 offset:20480
    ds_read_b64_tr_b16 v[98:99], v5 offset:21504
    ds_read_b128 v[100:103], v6 offset:20480
    ds_read_b128 v[104:107], v6 offset:24576
    ds_read_b128 v[108:111], v6 offset:28672
    v_mfma_f32_32x32x16_bf16 v[32:47], v[80:83], v[84:87], v[32:47]
    v_mfma_f32_32x32x16_bf16 v[48:63], v[80:83], v[88:91], v[48:63]
    v_mfma_f32_32x32x16_bf16 v[64:79], v[80:83], v[92:95], v[64:79]
    s_mul_i32 s23, s34, 81920
    s_add_u32 s23, s23, s26
    s_add_u32 m0, s27, 0
    s_lshl_b32 s24, s34, 12
    buffer_load_dwordx4 v3, s[4:7], s23 offen lds
    s_add_u32 m0, s37, 0
    s_add_u32 s22, s24, s36
    buffer_load_dwordx4 v2, s[12:15], s22 offen sc1 lds
    s_cmp_lt_u32 s16, 4
    s_cbranch_scc0 g2_d4_25
    s_add_u32 m0, s37, 8192
    s_add_u32 s22, s22, 221184
    buffer_load_dwordx4 v2, s[12:15], s22 offen sc1 lds
g2_d4_25:
    s_add_u32 s34, s34, 1
    s_cmp_eq_u32 s34, 27
    s_cselect_b32 s34, 0, s34
    s_bitcmp1_b32 s41, s16
    s_cbranch_scc0 g2_w4_22a
    s_waitcnt vmcnt(6) lgkmcnt(0)
    s_branch g2_w4_22b
g2_w4_22a:
    s_waitcnt vmcnt(4) lgkmcnt(0)
g2_w4_22b:
    s_barrier
    ds_read_b64_tr_b16 v[80:81], v5 offset:40960
    ds_read_b64_tr_b16 v[82:83], v5 offset:41984
    ds_read_b128 v[84:87], v7 offset:8192
    ds_read_b128 v[88:91], v7 offset:12288
    ds_read_b128 v[92:95], v7 offset:16384
    v_mfma_f32_32x32x16_bf16 v[32:47], v[96:99], v[100:103], v[32:47]
    v_mfma_f32_32x32x16_bf16 v[48:63], v[96:99], v[104:107], v[48:63]
    v_mfma_f32_32x32x16_bf16 v[64:79], v[96:99], v[108:111], v[64:79]
    s_mul_i32 s23, s34, 81920
    s_add_u32 s23, s23, s26
    s_add_u32 m0, s27, 20480
    s_lshl_b32 s24, s34, 12
    buffer_load_dwordx4 v3, s[4:7], s23 offen lds
    s_add_u32 m0, s37, 20480
    s_add_u32 s22, s24, s36
    buffer_load_dwordx4 v2, s[12:15], s22 offen sc1 lds
    s_cmp_lt_u32 s16, 4
    s_cbranch_scc0 g2_d4_26
    s_add_u32 m0, s37, 28672
    s_add_u32 s22, s22, 221184
    buffer_load_dwordx4 v2, s[12:15], s22 offen sc1 lds
g2_d4_26:
    s_add_u32 s34, s34, 1
    s_cmp_eq_u32 s34, 27
    s_cselect_b32 s34, 0, s34
    s_bitcmp1_b32 s41, s16
    s_cbranch_scc0 g2_w4_23a
    s_waitcnt vmcnt(6) lgkmcnt(0)
    s_branch g2_w4_23b
g2_w4_23a:
    s_waitcnt vmcnt(4) lgkmcnt(0)
g2_w4_23b:
    s_barrier
    ds_read_b64_tr_b16 v[96:97], v5 offset:61440
    ds_read_b64_tr_b16 v[98:99], v5 offset:62464
    ds_read_b128 v[100:103], v7 offset:28672
    ds_read_b128 v[104:107], v7 offset:32768
    ds_read_b128 v[108:111], v7 offset:36864
    v_mfma_f32_32x32x16_bf16 v[32:47], v[80:83], v[84:87], v[32:47]
    v_mfma_f32_32x32x16_bf16 v[48:63], v[80:83], v[88:91], v[48:63]
    v_mfma_f32_32x32x16_bf16 v[64:79], v[80:83], v[92:95], v[64:79]
    s_mul_i32 s23, s34, 81920
    s_add_u32 s23, s23, s26
    s_add_u32 m0, s27, 40960
    s_lshl_b32 s24, s34, 12
    buffer_load_dwordx4 v3, s[4:7], s23 offen lds
    s_add_u32 m0, s37, 40960
    s_add_u32 s22, s24, s36
    buffer_load_dwordx4 v2, s[12:15], s22 offen sc1 lds
    s_cmp_lt_u32 s16, 4
    s_cbranch_scc0 g2_d4_27
    s_add_u32 m0, s37, 49152
    s_add_u32 s22, s22, 221184
    buffer_load_dwordx4 v2, s[12:15], s22 offen sc1 lds
g2_d4_27:
    s_add_u32 s34, s34, 1
    s_cmp_eq_u32 s34, 27
    s_cselect_b32 s34, 0, s34
    s_bitcmp1_b32 s41, s16
    s_cbranch_scc0 g2_w4_24a
    s_waitcnt vmcnt(6) lgkmcnt(0)
    s_branch g2_w4_24b
g2_w4_24a:
    s_waitcnt vmcnt(4) lgkmcnt(0)
g2_w4_24b:
    s_barrier
    ds_read_b64_tr_b16 v[80:81], v5 offset:0
    ds_read_b64_tr_b16 v[82:83], v5 offset:1024
    ds_read_b128 v[84:87], v6 offset:0
    ds_read_b128 v[88:91], v6 offset:4096
    ds_read_b128 v[92:95], v6 offset:8192
    v_mfma_f32_32x32x16_bf16 v[32:47], v[96:99], v[100:103], v[32:47]
    v_mfma_f32_32x32x16_bf16 v[48:63], v[96:99], v[104:107], v[48:63]
    v_mfma_f32_32x32x16_bf16 v[64:79], v[96:99], v[108:111], v[64:79]
    s_bitcmp1_b32 s41, s16
    s_cbranch_scc0 g2_w4_25a
    s_waitcnt vmcnt(3) lgkmcnt(0)
    s_branch g2_w4_25b
g2_w4_25a:
    s_waitcnt vmcnt(2) lgkmcnt(0)
g2_w4_25b:
    s_barrier
    ds_read_b64_tr_b16 v[96:97], v5 offset:20480
    ds_read_b64_tr_b16 v[98:99], v5 offset:21504
    ds_read_b128 v[100:103], v6 offset:20480
    ds_read_b128 v[104:107], v6 offset:24576
    ds_read_b128 v[108:111], v6 offset:28672
    v_mfma_f32_32x32x16_bf16 v[32:47], v[80:83], v[84:87], v[32:47]
    v_mfma_f32_32x32x16_bf16 v[48:63], v[80:83], v[88:91], v[48:63]
    v_mfma_f32_32x32x16_bf16 v[64:79], v[80:83], v[92:95], v[64:79]
    s_bitcmp1_b32 s41, s16
    s_cbranch_scc0 g2_w4_26a
    s_waitcnt vmcnt(0) lgkmcnt(0)
    s_branch g2_w4_26b
g2_w4_26a:
    s_waitcnt vmcnt(0) lgkmcnt(0)
g2_w4_26b:
    s_barrier
    ds_read_b64_tr_b16 v[80:81], v5 offset:40960
    ds_read_b64_tr_b16 v[82:83], v5 offset:41984
    ds_read_b128 v[84:87], v7 offset:8192
    ds_read_b128 v[88:91], v7 offset:12288
    ds_read_b128 v[92:95], v7 offset:16384
    v_mfma_f32_32x32x16_bf16 v[32:47], v[96:99], v[100:103], v[32:47]
    v_mfma_f32_32x32x16_bf16 v[48:63], v[96:99], v[104:107], v[48:63]
    v_mfma_f32_32x32x16_bf16 v[64:79], v[96:99], v[108:111], v[64:79]
    s_waitcnt lgkmcnt(0)
    v_mfma_f32_32x32x16_bf16 v[32:47], v[80:83], v[84:87], v[32:47]
    v_mfma_f32_32x32x16_bf16 v[48:63], v[80:83], v[88:91], v[48:63]
    v_mfma_f32_32x32x16_bf16 v[64:79], v[80:83], v[92:95], v[64:79]
    s_setprio 3
    v_sub_f32 v8, 1.0, v8
    v_sub_f32 v9, 1.0, v9
    v_sub_f32 v10, 1.0, v10
    s_nop 5
    v_mul_f32 v32, v32, v8
    v_mul_f32 v33, v33, v8
    v_mul_f32 v34, v34, v8
    v_mul_f32 v35, v35, v8
    v_mul_f32 v36, v36, v8
    v_mul_f32 v37, v37, v8
    v_mul_f32 v38, v38, v8
    v_mul_f32 v39, v39, v8
    v_mul_f32 v40, v40, v8
    v_mul_f32 v41, v41, v8
    v_mul_f32 v42, v42, v8
    v_mul_f32 v43, v43, v8
    v_mul_f32 v44, v44, v8
    v_mul_f32 v45, v45, v8
    v_mul_f32 v46, v46, v8
    v_mul_f32 v47, v47, v8
    v_mul_f32 v48, v48, v9
    v_mul_f32 v49, v49, v9
    v_mul_f32 v50, v50, v9
    v_mul_f32 v51, v51, v9
    v_mul_f32 v52, v52, v9
    v_mul_f32 v53, v53, v9
    v_mul_f32 v54, v54, v9
    v_mul_f32 v55, v55, v9
    v_mul_f32 v56, v56, v9
    v_mul_f32 v57, v57, v9
    v_mul_f32 v58, v58, v9
    v_mul_f32 v59, v59, v9
    v_mul_f32 v60, v60, v9
    v_mul_f32 v61, v61, v9
    v_mul_f32 v62, v62, v9
    v_mul_f32 v63, v63, v9
    v_mul_f32 v64, v64, v10
    v_mul_f32 v65, v65, v10
    v_mul_f32 v66, v66, v10
    v_mul_f32 v67, v67, v10
    v_mul_f32 v68, v68, v10
    v_mul_f32 v69, v69, v10
    v_mul_f32 v70, v70, v10
    v_mul_f32 v71, v71, v10
    v_mul_f32 v72, v72, v10
    v_mul_f32 v73, v73, v10
    v_mul_f32 v74, v74, v10
    v_mul_f32 v75, v75, v10
    v_mul_f32 v76, v76, v10
    v_mul_f32 v77, v77, v10
    v_mul_f32 v78, v78, v10
    v_mul_f32 v79, v79, v10
    v_add_u32 v6, 8192, v6
    v_lshrrev_b32 v12, 3, v1
    s_lshl_b32 s22, s16, 4
    s_add_u32 s22, s22, 0
    v_add_u32 v12, s22, v12
    v_lshrrev_b32 v13, 4, v12
    v_mul_u32_u24 v13, 20, v13
    v_and_b32 v14, 15, v12
    v_add_u32 v13, v13, v14
    v_mul_u32_u24 v13, 1280, v13
    v_bfe_u32 v14, v1, 2, 1
    v_bfe_u32 v15, v12, 1, 1
    v_xor_b32 v14, v14, v15
    v_lshlrev_b32 v14, 6, v14
    v_and_b32 v15, 3, v1
    v_lshlrev_b32 v15, 4, v15
    v_add3_u32 v3, v13, v14, v15
    v_lshrrev_b32 v12, 3, v1
    s_lshl_b32 s22, s16, 4
    s_add_u32 s22, s22, 8
    v_add_u32 v12, s22, v12
    v_lshrrev_b32 v13, 4, v12
    v_mul_u32_u24 v13, 20, v13
    v_and_b32 v14, 15, v12
    v_add_u32 v13, v13, v14
    v_mul_u32_u24 v13, 1280, v13
    v_bfe_u32 v14, v1, 2, 1
    v_bfe_u32 v15, v12, 1, 1
    v_xor_b32 v14, v14, v15
    v_lshlrev_b32 v14, 6, v14
    v_and_b32 v15, 3, v1
    v_lshlrev_b32 v15, 4, v15
    v_add3_u32 v4, v13, v14, v15
    s_lshr_b32 s22, s3, 3
    s_mul_i32 s23, s22, 52429
    s_lshr_b32 s23, s23, 18
    s_mul_i32 s23, s23, 5
    s_sub_u32 s22, s22, s23
    s_and_b32 s35, s22, 3
    s_mul_i32 s35, s35, 1
    s_barrier
    s_add_u32 s23, s35, 0
    s_and_b32 s23, s23, 3
    s_mul_i32 s23, s23, 204800
    s_add_u32 s23, s23, s26
    s_add_u32 m0, s21, 0
    s_nop 0
    buffer_load_dwordx4 v3, s[8:11], s23 offen lds
    s_add_u32 m0, s21, 1024
    s_nop 0
    buffer_load_dwordx4 v4, s[8:11], s23 offen lds
    s_add_u32 s23, s35, 1
    s_and_b32 s23, s23, 3
    s_mul_i32 s23, s23, 204800
    s_add_u32 s23, s23, s26
    s_add_u32 m0, s21, 16384
    s_nop 0
    buffer_load_dwordx4 v3, s[8:11], s23 offen lds
    s_add_u32 m0, s21, 17408
    s_nop 0
    buffer_load_dwordx4 v4, s[8:11], s23 offen lds
    s_add_u32 s23, s35, 2
    s_and_b32 s23, s23, 3
    s_mul_i32 s23, s23, 204800
    s_add_u32 s23, s23, s26
    s_add_u32 m0, s21, 32768
    s_nop 0
    buffer_load_dwordx4 v3, s[8:11], s23 offen lds
    s_add_u32 m0, s21, 33792
    s_nop 0
    buffer_load_dwordx4 v4, s[8:11], s23 offen lds
    s_add_u32 s23, s35, 3
    s_and_b32 s23, s23, 3
    s_mul_i32 s23, s23, 204800
    s_add_u32 s23, s23, s26
    s_add_u32 m0, s21, 49152
    s_nop 0
    buffer_load_dwordx4 v3, s[8:11], s23 offen lds
    s_add_u32 m0, s21, 50176
    s_nop 0
    buffer_load_dwordx4 v4, s[8:11], s23 offen lds
    v_lshrrev_b32 v12, 3, v1
    s_lshl_b32 s22, s16, 4
    s_add_u32 s22, s22, 0
    v_add_u32 v12, s22, v12
    v_lshrrev_b32 v13, 4, v12
    v_lshlrev_b32 v13, 2, v13
    v_bfe_u32 v14, v12, 2, 1
    v_lshlrev_b32 v14, 1, v14
    v_bfe_u32 v15, v12, 3, 1
    v_add3_u32 v13, v13, v14, v15
    v_mul_u32_u24 v13, 20, v13
    v_and_b32 v14, 3, v12
    v_add3_u32 v13, v13, v14, 16
    v_mul_u32_u24 v13, 1280, v13
    v_bfe_u32 v14, v1, 2, 1
    v_bfe_u32 v15, v12, 1, 1
    v_xor_b32 v14, v14, v15
    v_lshlrev_b32 v14, 6, v14
    v_and_b32 v15, 3, v1
    v_lshlrev_b32 v15, 4, v15
    v_add3_u32 v3, v13, v14, v15
    v_lshrrev_b32 v12, 3, v1
    s_lshl_b32 s22, s16, 4
    s_add_u32 s22, s22, 8
    v_add_u32 v12, s22, v12
    v_lshrrev_b32 v13, 4, v12
    v_lshlrev_b32 v13, 2, v13
    v_bfe_u32 v14, v12, 2, 1
    v_lshlrev_b32 v14, 1, v14
    v_bfe_u32 v15, v12, 3, 1
    v_add3_u32 v13, v13, v14, v15
    v_mul_u32_u24 v13, 20, v13
    v_and_b32 v14, 3, v12
    v_add3_u32 v13, v13, v14, 16
    v_mul_u32_u24 v13, 1280, v13
    v_bfe_u32 v14, v1, 2, 1
    v_bfe_u32 v15, v12, 1, 1
    v_xor_b32 v14, v14, v15
    v_lshlrev_b32 v14, 6, v14
    v_and_b32 v15, 3, v1
    v_lshlrev_b32 v15, 4, v15
    v_add3_u32 v4, v13, v14, v15
    s_mov_b32 s23, s26
    s_add_u32 m0, s21, 65536
    s_nop 0
    buffer_load_dwordx4 v3, s[8:11], s23 offen lds
    s_add_u32 m0, s21, 66560
    s_nop 0
    buffer_load_dwordx4 v4, s[8:11], s23 offen lds
    v_add_u32 v7, 49152, v5
    s_waitcnt vmcnt(0)
    s_barrier
    ds_read_b64_tr_b16 v[80:81], v5 offset:0
    ds_read_b64_tr_b16 v[82:83], v5 offset:1024
    ds_read_b64_tr_b16 v[84:85], v5 offset:8192
    ds_read_b64_tr_b16 v[86:87], v5 offset:9216
    ds_read_b64_tr_b16 v[88:89], v5 offset:16384
    ds_read_b64_tr_b16 v[90:91], v5 offset:17408
    ds_read_b64_tr_b16 v[92:93], v5 offset:24576
    ds_read_b64_tr_b16 v[94:95], v5 offset:25600
    ds_read_b64_tr_b16 v[96:97], v5 offset:32768
    ds_read_b64_tr_b16 v[98:99], v5 offset:33792
    ds_read_b64_tr_b16 v[100:101], v5 offset:40960
    ds_read_b64_tr_b16 v[102:103], v5 offset:41984
    s_waitcnt lgkmcnt(0)
    ds_read_b64_tr_b16 v[104:105], v7 offset:0
    ds_read_b64_tr_b16 v[106:107], v7 offset:1024
    ds_read_b64_tr_b16 v[108:109], v7 offset:8192
    ds_read_b64_tr_b16 v[110:111], v7 offset:9216
    ds_read_b64_tr_b16 v[112:113], v7 offset:16384
    ds_read_b64_tr_b16 v[114:115], v7 offset:17408
    ds_read_b64_tr_b16 v[116:117], v7 offset:24576
    ds_read_b64_tr_b16 v[118:119], v7 offset:25600
    v_subrev_u32 v11, 16384, v6
    v_add_u32 v3, 49152, v11
    s_waitcnt lgkmcnt(0)
    s_barrier
    s_cmp_eq_u32 s3, 0
    s_cbranch_scc0 g2_noep
    s_cmp_eq_u32 s16, 0
    s_cbranch_scc0 g2_noep
    v_lshrrev_b32 v127, 2, v1
    v_mul_u32_u24 v127, 4352, v127
    v_and_b32 v125, 3, v1
    v_lshl_add_u32 v127, v125, 4, v127
    v_add_u32 v125, 20482048, v127
    v_add_u32 v127, 19922944, v127
    s_mov_b32 s51, 100000
g2_ep:
    buffer_load_dwordx4 v[12:15], v127, s[12:15], 0 offen sc1
    buffer_load_dwordx4 v[16:19], v125, s[12:15], 0 offen sc1
    s_waitcnt vmcnt(0)
    v_xor_b32 v12, s60, v12
    v_xor_b32 v13, s60, v13
    v_xor_b32 v14, s60, v14
    v_xor_b32 v15, s60, v15
    v_xor_b32 v16, s60, v16
    v_xor_b32 v17, s60, v17
    v_xor_b32 v18, s60, v18
    v_xor_b32 v19, s60, v19
    v_or3_b32 v12, v12, v13, v14
    v_or3_b32 v16, v16, v17, v18
    v_or3_b32 v12, v12, v15, v19
    v_or_b32 v12, v12, v16
    v_cmp_ne_u32 vcc, 0, v12
    s_nop 1
    s_cmp_eq_u64 vcc, 0
    s_cbranch_scc1 g2_epok
    s_sleep 8
    s_sub_u32 s51, s51, 1
    s_cmp_lg_u32 s51, 0
    s_cbranch_scc1 g2_ep
    s_branch g2_noep
g2_epok:
    s_mov_b32 s50, 18972672
    v_mov_b32 v126, s60
    v_mov_b32 v127, 0
    s_mov_b64 exec, 1
    buffer_store_dword v126, v127, s[12:15], s50 offen sc1
    s_mov_b64 exec, -1
g2_noep:
    s_cmp_eq_u32 s16, 0
    s_cbranch_scc0 g2_wo_join
    s_mul_i32 s50, s17, 3
    v_lshrrev_b32 v124, 4, v1
    v_min_u32 v124, 2, v124
    v_add_u32 v124, s50, v124
    v_min_u32 v124, 63, v124
    v_mul_u32_u24 v124, 4352, v124
    v_and_b32 v125, 15, v1
    v_lshl_add_u32 v124, v125, 3, v124
    v_add_u32 v127, 20551680, v124
    s_mov_b32 s51, 100000
g2_wo_poll:
    buffer_load_dwordx2 v[124:125], v127, s[12:15], 0 offen sc1
    s_waitcnt vmcnt(0)
    v_xor_b32 v124, s60, v124
    v_xor_b32 v125, s60, v125
    v_or_b32 v124, v124, v125
    v_cmp_ne_u32 vcc, 0, v124
    s_nop 1
    s_cmp_eq_u64 vcc, 0
    s_cbranch_scc1 g2_wo_ok
    s_sleep 4
    s_sub_u32 s51, s51, 1
    s_cmp_lg_u32 s51, 0
    s_cbranch_scc1 g2_wo_poll
g2_wo_ok:
g2_wo_join:
    s_barrier
    s_add_u32 s23, s35, 0
    s_and_b32 s23, s23, 3
    s_lshl_b32 s23, s23, 13
    s_add_u32 s23, s23, s28
    s_add_u32 m0, s27, 0
    s_add_u32 s22, s23, 0
    buffer_load_dwordx4 v2, s[12:15], s22 offen sc1 lds
    s_add_u32 m0, s27, 8192
    s_add_u32 s22, s23, 40960
    buffer_load_dwordx4 v2, s[12:15], s22 offen sc1 lds
    s_add_u32 m0, s27, 16384
    s_add_u32 s22, s23, 81920
    buffer_load_dwordx4 v2, s[12:15], s22 offen sc1 lds
    s_add_u32 s23, s35, 1
    s_and_b32 s23, s23, 3
    s_lshl_b32 s23, s23, 13
    s_add_u32 s23, s23, s28
    s_add_u32 m0, s27, 24576
    s_add_u32 s22, s23, 0
    buffer_load_dwordx4 v2, s[12:15], s22 offen sc1 lds
    s_add_u32 m0, s27, 32768
    s_add_u32 s22, s23, 40960
    buffer_load_dwordx4 v2, s[12:15], s22 offen sc1 lds
    s_add_u32 m0, s27, 40960
    s_add_u32 s22, s23, 81920
    buffer_load_dwordx4 v2, s[12:15], s22 offen sc1 lds
    s_add_u32 s23, s35, 2
    s_and_b32 s23, s23, 3
    s_lshl_b32 s23, s23, 13
    s_add_u32 s23, s23, s28
    s_add_u32 m0, s27, 49152
    s_add_u32 s22, s23, 0
    buffer_load_dwordx4 v2, s[12:15], s22 offen sc1 lds
    s_add_u32 m0, s27, 57344
    s_add_u32 s22, s23, 40960
    buffer_load_dwordx4 v2, s[12:15], s22 offen sc1 lds
    s_add_u32 m0, s27, 65536
    s_add_u32 s22, s23, 81920
    buffer_load_dwordx4 v2, s[12:15], s22 offen sc1 lds
    s_waitcnt vmcnt(6)
    s_barrier
    ds_read_b128 v[12:15], v11 offset:0
    ds_read_b128 v[16:19], v11 offset:8192
    ds_read_b128 v[20:23], v11 offset:16384
    ds_read_b128 v[24:27], v11 offset:4096
    ds_read_b128 v[28:31], v11 offset:12288
    ds_read_b128 v[120:123], v11 offset:20480
    s_waitcnt lgkmcnt(3)
    v_mfma_f32_32x32x16_bf16 v[32:47], v[80:83], v[12:15], v[32:47]
    v_mfma_f32_32x32x16_bf16 v[48:63], v[80:83], v[16:19], v[48:63]
    v_mfma_f32_32x32x16_bf16 v[64:79], v[80:83], v[20:23], v[64:79]
    s_waitcnt lgkmcnt(0)
    v_mfma_f32_32x32x16_bf16 v[32:47], v[84:87], v[24:27], v[32:47]
    v_mfma_f32_32x32x16_bf16 v[48:63], v[84:87], v[28:31], v[48:63]
    v_mfma_f32_32x32x16_bf16 v[64:79], v[84:87], v[120:123], v[64:79]
    s_waitcnt vmcnt(3)
    s_barrier
    ds_read_b128 v[12:15], v11 offset:24576
    ds_read_b128 v[16:19], v11 offset:32768
    ds_read_b128 v[20:23], v11 offset:40960
    ds_read_b128 v[24:27], v11 offset:28672
    ds_read_b128 v[28:31], v11 offset:36864
    ds_read_b128 v[120:123], v11 offset:45056
    s_add_u32 s23, s35, 3
    s_and_b32 s23, s23, 3
    s_lshl_b32 s23, s23, 13
    s_add_u32 s23, s23, s28
    s_add_u32 m0, s27, 0
    s_add_u32 s22, s23, 0
    buffer_load_dwordx4 v2, s[12:15], s22 offen sc1 lds
    s_add_u32 m0, s27, 8192
    s_add_u32 s22, s23, 40960
    buffer_load_dwordx4 v2, s[12:15], s22 offen sc1 lds
    s_add_u32 m0, s27, 16384
    s_add_u32 s22, s23, 81920
    buffer_load_dwordx4 v2, s[12:15], s22 offen sc1 lds
    s_waitcnt lgkmcnt(3)
    v_mfma_f32_32x32x16_bf16 v[32:47], v[88:91], v[12:15], v[32:47]
    v_mfma_f32_32x32x16_bf16 v[48:63], v[88:91], v[16:19], v[48:63]
    v_mfma_f32_32x32x16_bf16 v[64:79], v[88:91], v[20:23], v[64:79]
    s_waitcnt lgkmcnt(0)
    v_mfma_f32_32x32x16_bf16 v[32:47], v[92:95], v[24:27], v[32:47]
    v_mfma_f32_32x32x16_bf16 v[48:63], v[92:95], v[28:31], v[48:63]
    v_mfma_f32_32x32x16_bf16 v[64:79], v[92:95], v[120:123], v[64:79]
    s_waitcnt vmcnt(3)
    s_barrier
    ds_read_b128 v[12:15], v3 offset:0
    ds_read_b128 v[16:19], v3 offset:8192
    ds_read_b128 v[20:23], v3 offset:16384
    ds_read_b128 v[24:27], v3 offset:4096
    ds_read_b128 v[28:31], v3 offset:12288
    ds_read_b128 v[120:123], v3 offset:20480
    s_add_u32 s23, s28, 32768
    s_add_u32 m0, s27, 24576
    s_add_u32 s22, s23, 0
    buffer_load_dwordx4 v2, s[12:15], s22 offen sc1 lds
    s_add_u32 m0, s27, 32768
    s_add_u32 s22, s23, 40960
    buffer_load_dwordx4 v2, s[12:15], s22 offen sc1 lds
    s_add_u32 m0, s27, 40960
    s_add_u32 s22, s23, 81920
    buffer_load_dwordx4 v2, s[12:15], s22 offen sc1 lds
    s_waitcnt lgkmcnt(3)
    v_mfma_f32_32x32x16_bf16 v[32:47], v[96:99], v[12:15], v[32:47]
    v_mfma_f32_32x32x16_bf16 v[48:63], v[96:99], v[16:19], v[48:63]
    v_mfma_f32_32x32x16_bf16 v[64:79], v[96:99], v[20:23], v[64:79]
    s_waitcnt lgkmcnt(0)
    v_mfma_f32_32x32x16_bf16 v[32:47], v[100:103], v[24:27], v[32:47]
    v_mfma_f32_32x32x16_bf16 v[48:63], v[100:103], v[28:31], v[48:63]
    v_mfma_f32_32x32x16_bf16 v[64:79], v[100:103], v[120:123], v[64:79]
    s_waitcnt vmcnt(3)
    s_barrier
    ds_read_b128 v[12:15], v11 offset:0
    ds_read_b128 v[16:19], v11 offset:8192
    ds_read_b128 v[20:23], v11 offset:16384
    ds_read_b128 v[24:27], v11 offset:4096
    ds_read_b128 v[28:31], v11 offset:12288
    ds_read_b128 v[120:123], v11 offset:20480
    s_waitcnt lgkmcnt(3)
    v_mfma_f32_32x32x16_bf16 v[32:47], v[104:107], v[12:15], v[32:47]
    v_mfma_f32_32x32x16_bf16 v[48:63], v[104:107], v[16:19], v[48:63]
    v_mfma_f32_32x32x16_bf16 v[64:79], v[104:107], v[20:23], v[64:79]
    s_waitcnt lgkmcnt(0)
    v_mfma_f32_32x32x16_bf16 v[32:47], v[108:111], v[24:27], v[32:47]
    v_mfma_f32_32x32x16_bf16 v[48:63], v[108:111], v[28:31], v[48:63]
    v_mfma_f32_32x32x16_bf16 v[64:79], v[108:111], v[120:123], v[64:79]
    s_waitcnt vmcnt(0)
    s_barrier
    ds_read_b128 v[12:15], v11 offset:24576
    ds_read_b128 v[16:19], v11 offset:32768
    ds_read_b128 v[20:23], v11 offset:40960
    ds_read_b128 v[24:27], v11 offset:28672
    ds_read_b128 v[28:31], v11 offset:36864
    ds_read_b128 v[120:123], v11 offset:45056
    s_waitcnt lgkmcnt(3)
    v_mfma_f32_32x32x16_bf16 v[32:47], v[112:115], v[12:15], v[32:47]
    v_mfma_f32_32x32x16_bf16 v[48:63], v[112:115], v[16:19], v[48:63]
    v_mfma_f32_32x32x16_bf16 v[64:79], v[112:115], v[20:23], v[64:79]
    s_waitcnt lgkmcnt(0)
    v_mfma_f32_32x32x16_bf16 v[32:47], v[116:119], v[24:27], v[32:47]
    v_mfma_f32_32x32x16_bf16 v[48:63], v[116:119], v[28:31], v[48:63]
    v_mfma_f32_32x32x16_bf16 v[64:79], v[116:119], v[120:123], v[64:79]
    s_barrier
    s_cmp_eq_u32 s20, 1
    s_cbranch_scc1 g2_r1
    s_cmp_eq_u32 s20, 2
    s_cbranch_scc1 g2_r2
    s_cmp_eq_u32 s20, 3
    s_cbranch_scc1 g2_r3
    s_mul_i32 s22, s19, 9216
    v_add_u32 v12, s22, v2
    s_nop 0
    ds_write_b128 v12, v[36:39] offset:18432
    ds_write_b128 v12, v[52:55] offset:19456
    ds_write_b128 v12, v[68:71] offset:20480
    ds_write_b128 v12, v[40:43] offset:36864
    ds_write_b128 v12, v[56:59] offset:37888
    ds_write_b128 v12, v[72:75] offset:38912
    ds_write_b128 v12, v[44:47] offset:55296
    ds_write_b128 v12, v[60:63] offset:56320
    ds_write_b128 v12, v[76:79] offset:57344
    s_waitcnt lgkmcnt(0)
    s_barrier
    ds_read_b128 v[80:83], v12 offset:0
    ds_read_b128 v[84:87], v12 offset:1024
    ds_read_b128 v[88:91], v12 offset:2048
    ds_read_b128 v[92:95], v12 offset:3072
    ds_read_b128 v[96:99], v12 offset:4096
    ds_read_b128 v[100:103], v12 offset:5120
    ds_read_b128 v[104:107], v12 offset:6144
    ds_read_b128 v[108:111], v12 offset:7168
    ds_read_b128 v[112:115], v12 offset:8192
    s_waitcnt lgkmcnt(0)
    v_add_f32 v16, v32, v80
    v_add_f32 v92, v92, v104
    v_add_f32 v16, v16, v92
    v_add_f32 v17, v33, v81
    v_add_f32 v93, v93, v105
    v_add_f32 v17, v17, v93
    v_add_f32 v18, v34, v82
    v_add_f32 v94, v94, v106
    v_add_f32 v18, v18, v94
    v_add_f32 v19, v35, v83
    v_add_f32 v95, v95, v107
    v_add_f32 v19, v19, v95
    v_add_f32 v20, v48, v84
    v_add_f32 v96, v96, v108
    v_add_f32 v20, v20, v96
    v_add_f32 v21, v49, v85
    v_add_f32 v97, v97, v109
    v_add_f32 v21, v21, v97
    v_add_f32 v22, v50, v86
    v_add_f32 v98, v98, v110
    v_add_f32 v22, v22, v98
    v_add_f32 v23, v51, v87
    v_add_f32 v99, v99, v111
    v_add_f32 v23, v23, v99
    v_add_f32 v24, v64, v88
    v_add_f32 v100, v100, v112
    v_add_f32 v24, v24, v100
    v_add_f32 v25, v65, v89
    v_add_f32 v101, v101, v113
    v_add_f32 v25, v25, v101
    v_add_f32 v26, v66, v90
    v_add_f32 v102, v102, v114
    v_add_f32 v26, v26, v102
    v_add_f32 v27, v67, v91
    v_add_f32 v103, v103, v115
    v_add_f32 v27, v27, v103
    s_branch g2_store
g2_r1:
    s_mul_i32 s22, s19, 9216
    v_add_u32 v12, s22, v2
    s_nop 4
    ds_write_b128 v12, v[32:35] offset:0
    ds_write_b128 v12, v[48:51] offset:1024
    ds_write_b128 v12, v[64:67] offset:2048
    ds_write_b128 v12, v[40:43] offset:39936
    ds_write_b128 v12, v[56:59] offset:40960
    ds_write_b128 v12, v[72:75] offset:41984
    ds_write_b128 v12, v[44:47] offset:58368
    ds_write_b128 v12, v[60:63] offset:59392
    ds_write_b128 v12, v[76:79] offset:60416
    s_waitcnt lgkmcnt(0)
    s_barrier
    ds_read_b128 v[80:83], v12 offset:18432
    ds_read_b128 v[84:87], v12 offset:19456
    ds_read_b128 v[88:91], v12 offset:20480
    ds_read_b128 v[92:95], v12 offset:21504
    ds_read_b128 v[96:99], v12 offset:22528
    ds_read_b128 v[100:103], v12 offset:23552
    ds_read_b128 v[104:107], v12 offset:24576
    ds_read_b128 v[108:111], v12 offset:25600
    ds_read_b128 v[112:115], v12 offset:26624
    s_waitcnt lgkmcnt(0)
    v_add_f32 v16, v36, v80
    v_add_f32 v92, v92, v104
    v_add_f32 v16, v16, v92
    v_add_f32 v17, v37, v81
    v_add_f32 v93, v93, v105
    v_add_f32 v17, v17, v93
    v_add_f32 v18, v38, v82
    v_add_f32 v94, v94, v106
    v_add_f32 v18, v18, v94
    v_add_f32 v19, v39, v83
    v_add_f32 v95, v95, v107
    v_add_f32 v19, v19, v95
    v_add_f32 v20, v52, v84
    v_add_f32 v96, v96, v108
    v_add_f32 v20, v20, v96
    v_add_f32 v21, v53, v85
    v_add_f32 v97, v97, v109
    v_add_f32 v21, v21, v97
    v_add_f32 v22, v54, v86
    v_add_f32 v98, v98, v110
    v_add_f32 v22, v22, v98
    v_add_f32 v23, v55, v87
    v_add_f32 v99, v99, v111
    v_add_f32 v23, v23, v99
    v_add_f32 v24, v68, v88
    v_add_f32 v100, v100, v112
    v_add_f32 v24, v24, v100
    v_add_f32 v25, v69, v89
    v_add_f32 v101, v101, v113
    v_add_f32 v25, v25, v101
    v_add_f32 v26, v70, v90
    v_add_f32 v102, v102, v114
    v_add_f32 v26, v26, v102
    v_add_f32 v27, v71, v91
    v_add_f32 v103, v103, v115
    v_add_f32 v27, v27, v103
    s_branch g2_store
g2_r2:
    s_mul_i32 s22, s19, 9216
    v_add_u32 v12, s22, v2
    s_nop 2
    ds_write_b128 v12, v[32:35] offset:3072
    ds_write_b128 v12, v[48:51] offset:4096
    ds_write_b128 v12, v[64:67] offset:5120
    ds_write_b128 v12, v[36:39] offset:21504
    ds_write_b128 v12, v[52:55] offset:22528
    ds_write_b128 v12, v[68:71] offset:23552
    ds_write_b128 v12, v[44:47] offset:61440
    ds_write_b128 v12, v[60:63] offset:62464
    ds_write_b128 v12, v[76:79] offset:63488
    s_waitcnt lgkmcnt(0)
    s_barrier
    ds_read_b128 v[80:83], v12 offset:36864
    ds_read_b128 v[84:87], v12 offset:37888
    ds_read_b128 v[88:91], v12 offset:38912
    ds_read_b128 v[92:95], v12 offset:39936
    ds_read_b128 v[96:99], v12 offset:40960
    ds_read_b128 v[100:103], v12 offset:41984
    ds_read_b128 v[104:107], v12 offset:43008
    ds_read_b128 v[108:111], v12 offset:44032
    ds_read_b128 v[112:115], v12 offset:45056
    s_waitcnt lgkmcnt(0)
    v_add_f32 v16, v40, v80
    v_add_f32 v92, v92, v104
    v_add_f32 v16, v16, v92
    v_add_f32 v17, v41, v81
    v_add_f32 v93, v93, v105
    v_add_f32 v17, v17, v93
    v_add_f32 v18, v42, v82
    v_add_f32 v94, v94, v106
    v_add_f32 v18, v18, v94
    v_add_f32 v19, v43, v83
    v_add_f32 v95, v95, v107
    v_add_f32 v19, v19, v95
    v_add_f32 v20, v56, v84
    v_add_f32 v96, v96, v108
    v_add_f32 v20, v20, v96
    v_add_f32 v21, v57, v85
    v_add_f32 v97, v97, v109
    v_add_f32 v21, v21, v97
    v_add_f32 v22, v58, v86
    v_add_f32 v98, v98, v110
    v_add_f32 v22, v22, v98
    v_add_f32 v23, v59, v87
    v_add_f32 v99, v99, v111
    v_add_f32 v23, v23, v99
    v_add_f32 v24, v72, v88
    v_add_f32 v100, v100, v112
    v_add_f32 v24, v24, v100
    v_add_f32 v25, v73, v89
    v_add_f32 v101, v101, v113
    v_add_f32 v25, v25, v101
    v_add_f32 v26, v74, v90
    v_add_f32 v102, v102, v114
    v_add_f32 v26, v26, v102
    v_add_f32 v27, v75, v91
    v_add_f32 v103, v103, v115
    v_add_f32 v27, v27, v103
    s_branch g2_store
g2_r3:
    s_mul_i32 s22, s19, 9216
    v_add_u32 v12, s22, v2
    s_nop 0
    ds_write_b128 v12, v[32:35] offset:6144
    ds_write_b128 v12, v[48:51] offset:7168
    ds_write_b128 v12, v[64:67] offset:8192
    ds_write_b128 v12, v[36:39] offset:24576
    ds_write_b128 v12, v[52:55] offset:25600
    ds_write_b128 v12, v[68:71] offset:26624
    ds_write_b128 v12, v[40:43] offset:43008
    ds_write_b128 v12, v[56:59] offset:44032
    ds_write_b128 v12, v[72:75] offset:45056
    s_waitcnt lgkmcnt(0)
    s_barrier
    ds_read_b128 v[80:83], v12 offset:55296
    ds_read_b128 v[84:87], v12 offset:56320
    ds_read_b128 v[88:91], v12 offset:57344
    ds_read_b128 v[92:95], v12 offset:58368
    ds_read_b128 v[96:99], v12 offset:59392
    ds_read_b128 v[100:103], v12 offset:60416
    ds_read_b128 v[104:107], v12 offset:61440
    ds_read_b128 v[108:111], v12 offset:62464
    ds_read_b128 v[112:115], v12 offset:63488
    s_waitcnt lgkmcnt(0)
    v_add_f32 v16, v44, v80
    v_add_f32 v92, v92, v104
    v_add_f32 v16, v16, v92
    v_add_f32 v17, v45, v81
    v_add_f32 v93, v93, v105
    v_add_f32 v17, v17, v93
    v_add_f32 v18, v46, v82
    v_add_f32 v94, v94, v106
    v_add_f32 v18, v18, v94
    v_add_f32 v19, v47, v83
    v_add_f32 v95, v95, v107
    v_add_f32 v19, v19, v95
    v_add_f32 v20, v60, v84
    v_add_f32 v96, v96, v108
    v_add_f32 v20, v20, v96
    v_add_f32 v21, v61, v85
    v_add_f32 v97, v97, v109
    v_add_f32 v21, v21, v97
    v_add_f32 v22, v62, v86
    v_add_f32 v98, v98, v110
    v_add_f32 v22, v22, v98
    v_add_f32 v23, v63, v87
    v_add_f32 v99, v99, v111
    v_add_f32 v23, v23, v99
    v_add_f32 v24, v76, v88
    v_add_f32 v100, v100, v112
    v_add_f32 v24, v24, v100
    v_add_f32 v25, v77, v89
    v_add_f32 v101, v101, v113
    v_add_f32 v25, v25, v101
    v_add_f32 v26, v78, v90
    v_add_f32 v102, v102, v114
    v_add_f32 v26, v26, v102
    v_add_f32 v27, v79, v91
    v_add_f32 v103, v103, v115
    v_add_f32 v27, v27, v103
g2_store:
    v_cvt_pk_bf16_f32 v80, v16, v17
    v_cvt_pk_bf16_f32 v81, v18, v19
    v_cvt_pk_bf16_f32 v82, v20, v21
    v_cvt_pk_bf16_f32 v83, v22, v23
    v_cvt_pk_bf16_f32 v84, v24, v25
    v_cvt_pk_bf16_f32 v85, v26, v27
    v_and_b32 v12, 31, v1
    s_lshl_b32 s22, s19, 2
    s_add_u32 s22, s22, s20
    v_and_b32 v13, 7, v12
    v_xor_b32 v13, s22, v13
    v_lshlrev_b32 v13, 4, v13
    v_lshlrev_b32 v12, 7, v12
    v_lshrrev_b32 v14, 5, v1
    v_lshlrev_b32 v14, 3, v14
    v_add3_u32 v12, v12, v13, v14
    v_lshrrev_b32 v13, 3, v1
    s_lshl_b32 s22, s16, 3
    v_add_u32 v13, s22, v13
    v_and_b32 v14, 7, v13
    v_and_b32 v15, 7, v1
    v_xor_b32 v14, v14, v15
    v_lshlrev_b32 v14, 4, v14
    v_lshl_add_u32 v14, v13, 7, v14
    v_mul_u32_u24 v13, 1280, v13
    v_lshl_add_u32 v13, v15, 4, v13
    s_mul_i32 s22, s17, 122880
    s_lshl_b32 s23, s18, 7
    s_add_u32 s22, s22, s23
    s_barrier
    ds_write_b64 v12, v[80:81] offset:0
    ds_write_b64 v12, v[82:83] offset:4096
    ds_write_b64 v12, v[84:85] offset:8192
    s_waitcnt lgkmcnt(0)
    s_barrier
    ds_read_b128 v[88:91], v14
    s_cmp_lt_u32 s16, 4
    s_cbranch_scc0 g2_one
    ds_read_b128 v[92:95], v14 offset:8192
    s_add_u32 s23, s22, 81920
    s_waitcnt lgkmcnt(0)
    buffer_store_dwordx4 v[92:95], v13, s[44:47], s23 offen sc1
g2_one:
    s_waitcnt lgkmcnt(0)
    buffer_store_dwordx4 v[88:91], v13, s[44:47], s22 offen sc1
g2_done:
y_exit:
    s_endpgm

.section .rodata,"a"
.p2align 6
.amdhsa_kernel gated_mix__mha_block__swiglu_ffn__prompt_kernel
  .amdhsa_next_free_vgpr 128
  .amdhsa_next_free_sgpr 96
  .amdhsa_accum_offset 128
  .amdhsa_group_segment_fixed_size 0
  .amdhsa_kernarg_size 88
  .amdhsa_user_sgpr_count 2
  .amdhsa_user_sgpr_kernarg_segment_ptr 1
  .amdhsa_system_sgpr_workgroup_id_x 1
  .amdhsa_float_denorm_mode_32 3
.end_amdhsa_kernel
```
